```python
import torch

def _softmax(x, axis=-1):
    return torch.softmax(x, dim=axis)
def _gelu(x):
    return torch.nn.functional.gelu(x, approximate="tanh")
def _silu(x):
    return torch.nn.functional.silu(x)
def _sigmoid(x):
    return torch.sigmoid(x)
def _layernorm(x, axis=-1, eps=1e-5):
    m = x.mean(dim=axis, keepdim=True)
    v = x.var(dim=axis, keepdim=True, unbiased=False)
    return (x - m) / torch.sqrt(v + eps)
def _scatter_add(tgt, idx, src, axis=0):
    return tgt.clone().index_add_(axis, idx, src)
def _segment_sum(src, seg, n):
    out = torch.zeros((n,) + src.shape[1:], dtype=src.dtype)
    return out.index_add_(0, seg, src)
def _pad(x, pw):
    flat = tuple(v for pair in reversed(pw) for v in pair)
    return torch.nn.functional.pad(x, flat)

kernel_name = 'standalone__gqa_block_cached__decode'

def setup_inputs():

    _w = (lambda a: (lambda t: t.to(torch.bfloat16) if t.is_floating_point() else t)(torch.as_tensor(a)))
    B, Sq, D = 1, 1, 448
    Hq, Hkv, Sk, Dh = 16, 8, 8192, 256
    assert Hq % Hkv == 0, (Hq, Hkv)
    return {
        "x": _w((lambda *s: torch.randn(*s, dtype=torch.bfloat16) * 0.8)(B, Sq, D)),
        "k_cache": _w((lambda *s: torch.randn(*s, dtype=torch.bfloat16) * 0.8)(B, Hkv, Sk, Dh)),
        "v_cache": _w((lambda *s: torch.randn(*s, dtype=torch.bfloat16) * 0.05)(B, Hkv, Sk, Dh)),
        "wq": _w((lambda *s: torch.randn(*s, dtype=torch.bfloat16) * 0.8)(D, Hq * Dh) * (D ** -0.5)),
        "wo": _w((lambda *s: torch.randn(*s, dtype=torch.bfloat16) * 0.05)(Hq * Dh, D) * ((Hq * Dh) ** -0.5)),
    }

def reference(x, k_cache, v_cache, wq, wo):
    B, Sq, D = x.shape
    Hq, Dh = 16, 256
    Hkv = k_cache.shape[1]
    rep = Hq // Hkv
    q = (lambda x, *d: x.permute(*d))((x @ wq).reshape(B, Sq, Hq, Dh), 0, 2, 1, 3)
    k = (lambda x, n, axis: torch.repeat_interleave(x, n, dim=axis))(k_cache, rep, axis=1)
    v = (lambda x, n, axis: torch.repeat_interleave(x, n, dim=axis))(v_cache, rep, axis=1)
    scores = torch.einsum("bhqd,bhkd->bhqk", q, k) * (Dh ** -0.5)
    p = _softmax(scores, axis=-1)
    o = torch.einsum("bhqk,bhkd->bhqd", p, v)
    return (lambda x, *d: x.permute(*d))(o, 0, 2, 1, 3).reshape(B, Sq, Hq * Dh) @ wo
```

```asm
; @launch grid=(256,1,1) block=(576,1,1) lds=134272
.amdgcn_target "amdgcn-amd-amdhsa--gfx950"
.text
.globl standalone__gqa_block_cached__decode_kernel
.p2align 8
.type standalone__gqa_block_cached__decode_kernel,@function
standalone__gqa_block_cached__decode_kernel:
    s_cmp_ge_u32 s2, 256
    s_cbranch_scc1 L_end
    s_load_dwordx16 s[4:19], s[0:1], 0
    v_lshrrev_b32 v1, 6, v0
    v_and_b32 v0, 63, v0
    v_readfirstlane_b32 s50, v1
    s_getpc_b64 s[84:85]
L_pc:
    s_sub_u32 s84, s84, L_pc-standalone__gqa_block_cached__decode_kernel
    s_subb_u32 s85, s85, 0
    s_bfe_u32 s86, s2, 0x10003
    s_mul_i32 s86, s86, 9
    s_add_u32 s86, s86, s50
    s_lshl_b32 s86, s86, 10
    v_lshl_add_u32 v160, v0, 4, s86
    v_min_u32 v160, (L_codeend-standalone__gqa_block_cached__decode_kernel-16) & 0xfffffff0, v160
    global_load_dwordx4 v[164:167], v160, s[84:85]
    s_and_b32 s48, s2, 7
    s_lshr_b32 s49, s2, 3
    v_and_b32 v2, 15, v0
    v_lshrrev_b32 v3, 4, v0
    s_lshl_b32 s52, s48, 22
    s_lshl_b32 s53, s49, 17
    s_add_u32 s52, s52, s53
    s_lshl_b32 s58, s48, 5
    s_add_u32 s58, s58, s49
    s_cmp_eq_u32 s50, 0
    s_cbranch_scc1 L_comm
    s_cmp_ge_u32 s50, 5
    s_cbranch_scc1 L_vw
    s_barrier
    s_sub_u32 s50, s50, 1
    s_lshl_b32 s53, s50, 15
    s_add_u32 s52, s52, s53
    v_lshrrev_b32 v5, 5, v0
    v_and_b32 v4, 31, v0
    v_xor_b32 v4, v4, v5
    v_lshlrev_b32 v4, 4, v4
    v_lshl_add_u32 v4, v5, 9, v4
    s_lshl_b32 s91, s50, 1
    s_add_u32 s91, s91, s49
    s_add_u32 s91, s91, s48
    s_and_b32 s90, s91, 1
    s_lshl_b32 s90, s90, 7
    v_xor_b32 v4, s90, v4
    s_mov_b32 s93, 0
    s_waitcnt lgkmcnt(0)
    s_mov_b32 s20, s6
    s_and_b32 s21, s7, 0xffff
    s_mov_b32 s22, 33554432
    s_mov_b32 s23, 0x20000
L_kl:
    s_add_u32 s90, s91, s93
    s_and_b32 s90, s90, 7
    s_lshl_b32 s90, s90, 12
    s_add_u32 s54, s52, s90
    s_add_u32 m0, s53, s90
    v_xor_b32 v5, 0, v4
    s_waitcnt vmcnt(5)
    buffer_load_dwordx4 v5, s[20:23], s54 offen offset:0 nt lds
    v_xor_b32 v6, 32, v4
    s_waitcnt vmcnt(5)
    buffer_load_dwordx4 v6, s[20:23], s54 offen offset:1024 nt lds
    v_xor_b32 v5, 64, v4
    s_waitcnt vmcnt(5)
    buffer_load_dwordx4 v5, s[20:23], s54 offen offset:2048 nt lds
    v_xor_b32 v6, 96, v4
    s_waitcnt vmcnt(5)
    buffer_load_dwordx4 v6, s[20:23], s54 offen offset:3072 nt lds
    v_xor_b32 v4, 0x80, v4
    s_add_u32 s93, s93, 1
    s_cmp_lt_u32 s93, 8
    s_cbranch_scc1 L_kl
    v_mov_b32 v12, 134240
    v_mov_b32 v13, 1
    s_mov_b64 exec, 1
    ds_add_u32 v12, v13
    s_mov_b64 exec, -1
    s_load_dword s51, s[18:19], 0
    s_mov_b32 s56, 0x3db8aa3b
    v_add_u32 v8, 0, v3
    v_xor_b32 v8, v8, v2
    v_lshlrev_b32 v8, 4, v8
    v_lshl_add_u32 v8, v2, 9, v8
    v_add_u32 v8, s53, v8
    v_add_u32 v9, 4, v3
    v_xor_b32 v9, v9, v2
    v_lshlrev_b32 v9, 4, v9
    v_lshl_add_u32 v9, v2, 9, v9
    v_add_u32 v9, s53, v9
    v_add_u32 v10, 8, v3
    v_xor_b32 v10, v10, v2
    v_lshlrev_b32 v10, 4, v10
    v_lshl_add_u32 v10, v2, 9, v10
    v_add_u32 v10, s53, v10
    v_add_u32 v11, 12, v3
    v_xor_b32 v11, v11, v2
    v_lshlrev_b32 v11, 4, v11
    v_lshl_add_u32 v11, v2, 9, v11
    v_add_u32 v11, s53, v11
    v_lshrrev_b32 v40, 3, v2
    v_lshlrev_b32 v41, 9, v40
    v_lshl_add_u32 v41, v3, 4, v41
    v_add_u32 v41, 133120, v41
    v_mov_b32 v20, 0
    v_mov_b32 v21, 0
    v_mov_b32 v22, 0
    v_mov_b32 v23, 0
    v_mov_b32 v24, 0
    v_mov_b32 v25, 0
    v_mov_b32 v26, 0
    v_mov_b32 v27, 0
    v_mov_b32 v28, 0
    v_mov_b32 v29, 0
    v_mov_b32 v30, 0
    v_mov_b32 v31, 0
    v_mov_b32 v32, 0
    v_mov_b32 v33, 0
    v_mov_b32 v34, 0
    v_mov_b32 v35, 0
    v_mov_b32 v18, 0xffffff00
    s_waitcnt lgkmcnt(0)
    s_add_u32 s51, s51, 1
    s_and_b32 s59, s51, 0xff
    s_cmp_eq_u32 s59, 0
    s_addc_u32 s51, s51, 0
    s_bfe_u32 s97, s51, 0x40008
    s_lshl_b32 s97, s97, 22
    s_add_u32 s97, s97, 8388608
    v_lshlrev_b32 v42, 10, v40
    v_lshl_add_u32 v42, v3, 2, v42
    s_lshl_b32 s54, s50, 6
    s_add_u32 s54, s54, 131072
    v_add_u32 v42, s54, v42
    v_lshlrev_b32 v43, 4, v40
    v_add_u32 v43, 134144, v43
    s_lshl_b32 s54, s50, 2
    v_add_u32 v44, s54, v43
    v_mov_b32 v12, 134224
    s_mov_b32 s57, 0
L_kq:
    ds_read_b32 v13, v12
    s_waitcnt lgkmcnt(0)
    v_readfirstlane_b32 s59, v13
    s_cmp_eq_u32 s59, 1
    s_cbranch_scc1 L_kq_ok
    s_sleep 1
    s_add_u32 s57, s57, 1
    s_cmp_lt_u32 s57, 400000
    s_cbranch_scc1 L_kq
L_kq_ok:
    ds_read_b128 v[64:67], v41 offset:0
    ds_read_b128 v[68:71], v41 offset:64
    ds_read_b128 v[72:75], v41 offset:128
    ds_read_b128 v[76:79], v41 offset:192
    ds_read_b128 v[80:83], v41 offset:256
    ds_read_b128 v[84:87], v41 offset:320
    ds_read_b128 v[88:91], v41 offset:384
    ds_read_b128 v[92:95], v41 offset:448
    s_waitcnt vmcnt(0)
    ds_read_b128 v[96:99], v8 offset:0
    ds_read_b128 v[100:103], v9 offset:0
    ds_read_b128 v[104:107], v10 offset:0
    ds_read_b128 v[108:111], v11 offset:0
    ds_read_b128 v[112:115], v8 offset:256
    ds_read_b128 v[116:119], v9 offset:256
    ds_read_b128 v[120:123], v10 offset:256
    ds_read_b128 v[124:127], v11 offset:256
    ds_read_b128 v[128:131], v8 offset:8192
    ds_read_b128 v[132:135], v9 offset:8192
    ds_read_b128 v[136:139], v10 offset:8192
    ds_read_b128 v[140:143], v11 offset:8192
    ds_read_b128 v[144:147], v8 offset:8448
    ds_read_b128 v[148:151], v9 offset:8448
    ds_read_b128 v[152:155], v10 offset:8448
    ds_read_b128 v[156:159], v11 offset:8448
    s_waitcnt lgkmcnt(8)
    v_mfma_f32_16x16x32_bf16 v[20:23], v[96:99], v[64:67], v[20:23]
    v_mfma_f32_16x16x32_bf16 v[20:23], v[100:103], v[68:71], v[20:23]
    v_mfma_f32_16x16x32_bf16 v[20:23], v[104:107], v[72:75], v[20:23]
    v_mfma_f32_16x16x32_bf16 v[20:23], v[108:111], v[76:79], v[20:23]
    v_mfma_f32_16x16x32_bf16 v[20:23], v[112:115], v[80:83], v[20:23]
    v_mfma_f32_16x16x32_bf16 v[20:23], v[116:119], v[84:87], v[20:23]
    v_mfma_f32_16x16x32_bf16 v[20:23], v[120:123], v[88:91], v[20:23]
    v_mfma_f32_16x16x32_bf16 v[20:23], v[124:127], v[92:95], v[20:23]
    ds_read_b128 v[96:99], v8 offset:16384
    ds_read_b128 v[100:103], v9 offset:16384
    ds_read_b128 v[104:107], v10 offset:16384
    ds_read_b128 v[108:111], v11 offset:16384
    ds_read_b128 v[112:115], v8 offset:16640
    ds_read_b128 v[116:119], v9 offset:16640
    ds_read_b128 v[120:123], v10 offset:16640
    ds_read_b128 v[124:127], v11 offset:16640
    s_waitcnt lgkmcnt(8)
    v_mfma_f32_16x16x32_bf16 v[24:27], v[128:131], v[64:67], v[24:27]
    v_mfma_f32_16x16x32_bf16 v[24:27], v[132:135], v[68:71], v[24:27]
    v_mfma_f32_16x16x32_bf16 v[24:27], v[136:139], v[72:75], v[24:27]
    v_mfma_f32_16x16x32_bf16 v[24:27], v[140:143], v[76:79], v[24:27]
    v_mfma_f32_16x16x32_bf16 v[24:27], v[144:147], v[80:83], v[24:27]
    v_mfma_f32_16x16x32_bf16 v[24:27], v[148:151], v[84:87], v[24:27]
    v_mfma_f32_16x16x32_bf16 v[24:27], v[152:155], v[88:91], v[24:27]
    v_mfma_f32_16x16x32_bf16 v[24:27], v[156:159], v[92:95], v[24:27]
    ds_read_b128 v[128:131], v8 offset:24576
    ds_read_b128 v[132:135], v9 offset:24576
    ds_read_b128 v[136:139], v10 offset:24576
    ds_read_b128 v[140:143], v11 offset:24576
    ds_read_b128 v[144:147], v8 offset:24832
    ds_read_b128 v[148:151], v9 offset:24832
    ds_read_b128 v[152:155], v10 offset:24832
    ds_read_b128 v[156:159], v11 offset:24832
    s_waitcnt lgkmcnt(8)
    v_mfma_f32_16x16x32_bf16 v[28:31], v[96:99], v[64:67], v[28:31]
    v_mfma_f32_16x16x32_bf16 v[28:31], v[100:103], v[68:71], v[28:31]
    v_mfma_f32_16x16x32_bf16 v[28:31], v[104:107], v[72:75], v[28:31]
    v_mfma_f32_16x16x32_bf16 v[28:31], v[108:111], v[76:79], v[28:31]
    v_mfma_f32_16x16x32_bf16 v[28:31], v[112:115], v[80:83], v[28:31]
    v_mfma_f32_16x16x32_bf16 v[28:31], v[116:119], v[84:87], v[28:31]
    v_mfma_f32_16x16x32_bf16 v[28:31], v[120:123], v[88:91], v[28:31]
    v_mfma_f32_16x16x32_bf16 v[28:31], v[124:127], v[92:95], v[28:31]
    s_waitcnt lgkmcnt(0)
    v_mfma_f32_16x16x32_bf16 v[32:35], v[128:131], v[64:67], v[32:35]
    v_mfma_f32_16x16x32_bf16 v[32:35], v[132:135], v[68:71], v[32:35]
    v_mfma_f32_16x16x32_bf16 v[32:35], v[136:139], v[72:75], v[32:35]
    v_mfma_f32_16x16x32_bf16 v[32:35], v[140:143], v[76:79], v[32:35]
    v_mfma_f32_16x16x32_bf16 v[32:35], v[144:147], v[80:83], v[32:35]
    v_mfma_f32_16x16x32_bf16 v[32:35], v[148:151], v[84:87], v[32:35]
    v_mfma_f32_16x16x32_bf16 v[32:35], v[152:155], v[88:91], v[32:35]
    v_mfma_f32_16x16x32_bf16 v[32:35], v[156:159], v[92:95], v[32:35]
    s_nop 7
    v_max3_f32 v36, v20, v21, v22
    v_max3_f32 v37, v23, v24, v25
    v_max3_f32 v36, v36, v26, v27
    v_max3_f32 v37, v37, v28, v29
    v_max3_f32 v36, v36, v30, v31
    v_max3_f32 v37, v37, v32, v33
    v_max3_f32 v36, v36, v34, v35
    v_max_f32 v36, v36, v37
    v_mov_b32 v37, v36
    s_nop 1
    v_permlane16_swap_b32 v37, v36
    s_nop 1
    v_max_f32 v36, v36, v37
    v_mov_b32 v37, v36
    s_nop 1
    v_permlane32_swap_b32 v37, v36
    s_nop 1
    v_max_f32 v36, v36, v37
    s_mov_b64 exec, 0x101
    ds_write_b32 v44, v36
    s_mov_b64 exec, -1
    v_mov_b32 v12, 134228
    v_mov_b32 v13, 1
    s_mov_b64 exec, 1
    ds_add_u32 v12, v13
    s_mov_b64 exec, -1
    v_mov_b32 v12, 134228
    s_mov_b32 s57, 0
L_km:
    ds_read_b32 v13, v12
    s_waitcnt lgkmcnt(0)
    v_readfirstlane_b32 s59, v13
    s_cmp_eq_u32 s59, 4
    s_cbranch_scc1 L_km_ok
    s_add_u32 s57, s57, 1
    s_cmp_lt_u32 s57, 400000
    s_cbranch_scc1 L_km
L_km_ok:
    ds_read_b128 v[64:67], v43
    s_waitcnt lgkmcnt(0)
    v_max3_f32 v36, v64, v65, v66
    v_max_f32 v36, v36, v67
    v_mul_f32 v36, s56, v36
    v_bfi_b32 v36, v18, v36, s51
    v_fma_f32 v20, v20, s56, -v36
    v_fma_f32 v21, v21, s56, -v36
    v_fma_f32 v22, v22, s56, -v36
    v_fma_f32 v23, v23, s56, -v36
    v_fma_f32 v24, v24, s56, -v36
    v_fma_f32 v25, v25, s56, -v36
    v_fma_f32 v26, v26, s56, -v36
    v_fma_f32 v27, v27, s56, -v36
    v_fma_f32 v28, v28, s56, -v36
    v_fma_f32 v29, v29, s56, -v36
    v_fma_f32 v30, v30, s56, -v36
    v_fma_f32 v31, v31, s56, -v36
    v_fma_f32 v32, v32, s56, -v36
    v_fma_f32 v33, v33, s56, -v36
    v_fma_f32 v34, v34, s56, -v36
    v_fma_f32 v35, v35, s56, -v36
    v_exp_f32 v20, v20
    v_exp_f32 v21, v21
    v_exp_f32 v22, v22
    v_exp_f32 v23, v23
    v_exp_f32 v24, v24
    v_exp_f32 v25, v25
    v_exp_f32 v26, v26
    v_exp_f32 v27, v27
    v_exp_f32 v28, v28
    v_exp_f32 v29, v29
    v_exp_f32 v30, v30
    v_exp_f32 v31, v31
    v_exp_f32 v32, v32
    v_exp_f32 v33, v33
    v_exp_f32 v34, v34
    v_exp_f32 v35, v35
    s_nop 0
    v_add_f32 v37, v20, v21
    v_add_f32 v38, v22, v23
    v_add_f32 v37, v37, v24
    v_add_f32 v38, v38, v25
    v_add_f32 v37, v37, v26
    v_add_f32 v38, v38, v27
    v_add_f32 v37, v37, v28
    v_add_f32 v38, v38, v29
    v_add_f32 v37, v37, v30
    v_add_f32 v38, v38, v31
    v_add_f32 v37, v37, v32
    v_add_f32 v38, v38, v33
    v_add_f32 v37, v37, v34
    v_add_f32 v38, v38, v35
    v_add_f32 v37, v37, v38
    v_cvt_pk_bf16_f32 v20, v20, v20
    v_cvt_pk_bf16_f32 v21, v21, v21
    v_cvt_pk_bf16_f32 v22, v22, v22
    v_cvt_pk_bf16_f32 v23, v23, v23
    v_cvt_pk_bf16_f32 v24, v24, v24
    v_cvt_pk_bf16_f32 v25, v25, v25
    v_cvt_pk_bf16_f32 v26, v26, v26
    v_cvt_pk_bf16_f32 v27, v27, v27
    v_cvt_pk_bf16_f32 v28, v28, v28
    v_cvt_pk_bf16_f32 v29, v29, v29
    v_cvt_pk_bf16_f32 v30, v30, v30
    v_cvt_pk_bf16_f32 v31, v31, v31
    v_cvt_pk_bf16_f32 v32, v32, v32
    v_cvt_pk_bf16_f32 v33, v33, v33
    v_cvt_pk_bf16_f32 v34, v34, v34
    v_cvt_pk_bf16_f32 v35, v35, v35
    s_mov_b32 exec_lo, 0x01010101
    s_mov_b32 exec_hi, 0x01010101
    ds_write2_b32 v42, v20, v21 offset0:0 offset1:64
    ds_write2_b32 v42, v22, v23 offset0:128 offset1:192
    ds_write2_b32 v42, v24, v25 offset0:4 offset1:68
    ds_write2_b32 v42, v26, v27 offset0:132 offset1:196
    ds_write2_b32 v42, v28, v29 offset0:8 offset1:72
    ds_write2_b32 v42, v30, v31 offset0:136 offset1:200
    ds_write2_b32 v42, v32, v33 offset0:12 offset1:76
    ds_write2_b32 v42, v34, v35 offset0:140 offset1:204
    s_mov_b64 exec, -1
    v_mov_b32 v38, v37
    s_nop 1
    v_permlane16_swap_b32 v38, v37
    s_nop 1
    v_add_f32 v37, v37, v38
    v_mov_b32 v38, v37
    s_nop 1
    v_permlane32_swap_b32 v38, v37
    s_nop 1
    v_add_f32 v37, v37, v38
    v_add_u32 v44, 32, v44
    v_lshlrev_b32 v43, 2, v40
    v_add_u32 v43, 134208, v43
    s_mov_b64 exec, 0x101
    ds_write_b32 v44, v37
    ds_write_b32 v43, v36
    s_mov_b64 exec, -1
    s_waitcnt lgkmcnt(0)
    v_mov_b32 v12, 134232
    v_mov_b32 v13, 1
    s_mov_b64 exec, 1
    ds_add_u32 v12, v13
    s_mov_b64 exec, -1
    s_endpgm
L_vw:
    s_barrier
    s_sub_u32 s50, s50, 5
    s_and_b32 s53, s50, 1
    s_lshr_b32 s54, s50, 1
    s_lshl_b32 s3, s53, 8
    s_add_u32 s52, s52, s3
    s_lshl_b32 s3, s54, 16
    s_add_u32 s52, s52, s3
    v_lshlrev_b32 v7, 9, v3
    v_lshl_add_u32 v7, v2, 4, v7
    s_waitcnt lgkmcnt(0)
    s_mov_b32 s24, s8
    s_and_b32 s25, s9, 0xffff
    s_mov_b32 s26, 33554432
    s_mov_b32 s27, 0x20000
    s_mov_b32 s36, s18
    s_and_b32 s37, s19, 0xffff
    s_mov_b32 s38, 268435456
    s_mov_b32 s39, 0x20000
    s_load_dword s51, s[18:19], 0
    v_and_b32 v18, 1, v0
    v_lshlrev_b32 v18, 4, v18
    v_mov_b32 v19, 0xffff
    v_lshlrev_b32 v19, v18, v19
    v_bfe_u32 v18, v0, 1, 2
    v_cmp_eq_u32 vcc, 0, v18
    s_nop 1
    v_cndmask_b32 v14, 0, v19, vcc
    v_cmp_eq_u32 vcc, 1, v18
    s_nop 1
    v_cndmask_b32 v15, 0, v19, vcc
    v_cmp_eq_u32 vcc, 2, v18
    s_nop 1
    v_cndmask_b32 v16, 0, v19, vcc
    v_cmp_eq_u32 vcc, 3, v18
    s_nop 1
    v_cndmask_b32 v17, 0, v19, vcc
    v_mov_b32 v18, 0xffffff00
    v_add_u32 v19, 4096, v7
    v_mov_b32 v20, 0
    v_mov_b32 v21, 0
    v_mov_b32 v22, 0
    v_mov_b32 v23, 0
    v_lshrrev_b32 v4, 3, v2
    v_lshlrev_b32 v4, 10, v4
    v_lshl_add_u32 v4, v3, 8, v4
    s_lshl_b32 s3, s54, 7
    s_add_u32 s3, s3, 131072
    v_add_u32 v4, s3, v4
    v_lshlrev_b32 v6, 4, v0
    s_lshl_b32 s3, s53, 10
    v_add_u32 v6, s3, v6
    v_lshrrev_b32 v8, 1, v3
    v_lshrrev_b32 v9, 1, v2
    v_lshl_add_u32 v9, v8, 4, v9
    v_lshlrev_b32 v9, 12, v9
    v_and_b32 v10, 1, v2
    v_lshl_add_u32 v9, v10, 5, v9
    v_and_b32 v10, 1, v3
    v_lshl_add_u32 v9, v10, 4, v9
    s_lshl_b32 s3, s53, 15
    v_add_u32 v5, s3, v9
    v_lshlrev_b32 v9, 4, v8
    v_add_u32 v9, 134176, v9
    v_lshlrev_b32 v10, 2, v8
    v_add_u32 v10, 134208, v10
    s_lshl_b32 s55, s48, 17
    s_lshl_b32 s3, s49, 7
    s_add_u32 s55, s55, s3
    s_add_u32 s55, s55, 2097152
    s_waitcnt lgkmcnt(0)
    s_add_u32 s51, s51, 1
    s_and_b32 s59, s51, 0xff
    s_cmp_eq_u32 s59, 0
    s_addc_u32 s51, s51, 0
    s_bfe_u32 s97, s51, 0x40008
    s_lshl_b32 s97, s97, 22
    s_add_u32 s97, s97, 8388608
    s_lshl_b32 s91, s54, 2
    s_add_u32 s91, s91, s49
    s_add_u32 s91, s91, s48
    s_cmp_eq_u32 s54, 1
    s_cbranch_scc1 L_v2
    v_mov_b32 v12, 134240
    s_mov_b32 s57, 0
L_v1k:
    ds_read_b32 v13, v12
    s_waitcnt lgkmcnt(0)
    v_readfirstlane_b32 s59, v13
    s_cmp_ge_u32 s59, 1
    s_cbranch_scc1 L_v1k_ok
    s_sleep 1
    s_add_u32 s57, s57, 1
    s_cmp_lt_u32 s57, 400000
    s_cbranch_scc1 L_v1k
L_v1k_ok:
    s_add_u32 s90, s91, 0
    s_and_b32 s90, s90, 7
    s_lshl_b32 s90, s90, 13
    s_add_u32 s94, s52, s90
    buffer_load_dwordx4 v[32:35], v7, s[24:27], s94 offen offset:0 nt
    buffer_load_dwordx4 v[36:39], v7, s[24:27], s94 offen offset:2048 nt
    buffer_load_dwordx4 v[40:43], v19, s[24:27], s94 offen offset:0 nt
    buffer_load_dwordx4 v[44:47], v19, s[24:27], s94 offen offset:2048 nt
    s_add_u32 s90, s91, 1
    s_and_b32 s90, s90, 7
    s_lshl_b32 s90, s90, 13
    s_add_u32 s94, s52, s90
    buffer_load_dwordx4 v[48:51], v7, s[24:27], s94 offen offset:0 nt
    buffer_load_dwordx4 v[52:55], v7, s[24:27], s94 offen offset:2048 nt
    buffer_load_dwordx4 v[56:59], v19, s[24:27], s94 offen offset:0 nt
    buffer_load_dwordx4 v[60:63], v19, s[24:27], s94 offen offset:2048 nt
    s_add_u32 s90, s91, 2
    s_and_b32 s90, s90, 7
    s_lshl_b32 s90, s90, 13
    s_add_u32 s94, s52, s90
    buffer_load_dwordx4 v[64:67], v7, s[24:27], s94 offen offset:0 nt
    buffer_load_dwordx4 v[68:71], v7, s[24:27], s94 offen offset:2048 nt
    buffer_load_dwordx4 v[72:75], v19, s[24:27], s94 offen offset:0 nt
    buffer_load_dwordx4 v[76:79], v19, s[24:27], s94 offen offset:2048 nt
    s_add_u32 s90, s91, 3
    s_and_b32 s90, s90, 7
    s_lshl_b32 s90, s90, 13
    s_add_u32 s94, s52, s90
    s_waitcnt vmcnt(11)
    buffer_load_dwordx4 v[80:83], v7, s[24:27], s94 offen offset:0 nt
    s_waitcnt vmcnt(11)
    buffer_load_dwordx4 v[84:87], v7, s[24:27], s94 offen offset:2048 nt
    s_waitcnt vmcnt(11)
    buffer_load_dwordx4 v[88:91], v19, s[24:27], s94 offen offset:0 nt
    s_waitcnt vmcnt(11)
    buffer_load_dwordx4 v[92:95], v19, s[24:27], s94 offen offset:2048 nt
    s_add_u32 s90, s91, 4
    s_and_b32 s90, s90, 7
    s_lshl_b32 s90, s90, 13
    s_add_u32 s94, s52, s90
    s_waitcnt vmcnt(11)
    buffer_load_dwordx4 v[96:99], v7, s[24:27], s94 offen offset:0 nt
    s_waitcnt vmcnt(11)
    buffer_load_dwordx4 v[100:103], v7, s[24:27], s94 offen offset:2048 nt
    s_waitcnt vmcnt(11)
    buffer_load_dwordx4 v[104:107], v19, s[24:27], s94 offen offset:0 nt
    s_waitcnt vmcnt(11)
    buffer_load_dwordx4 v[108:111], v19, s[24:27], s94 offen offset:2048 nt
    s_add_u32 s90, s91, 5
    s_and_b32 s90, s90, 7
    s_lshl_b32 s90, s90, 13
    s_add_u32 s94, s52, s90
    s_waitcnt vmcnt(11)
    buffer_load_dwordx4 v[112:115], v7, s[24:27], s94 offen offset:0 nt
    s_waitcnt vmcnt(11)
    buffer_load_dwordx4 v[116:119], v7, s[24:27], s94 offen offset:2048 nt
    s_waitcnt vmcnt(11)
    buffer_load_dwordx4 v[120:123], v19, s[24:27], s94 offen offset:0 nt
    s_waitcnt vmcnt(11)
    buffer_load_dwordx4 v[124:127], v19, s[24:27], s94 offen offset:2048 nt
    s_add_u32 s90, s91, 6
    s_and_b32 s90, s90, 7
    s_lshl_b32 s90, s90, 13
    s_add_u32 s94, s52, s90
    s_waitcnt vmcnt(11)
    buffer_load_dwordx4 v[128:131], v7, s[24:27], s94 offen offset:0 nt
    s_waitcnt vmcnt(11)
    buffer_load_dwordx4 v[132:135], v7, s[24:27], s94 offen offset:2048 nt
    s_waitcnt vmcnt(11)
    buffer_load_dwordx4 v[136:139], v19, s[24:27], s94 offen offset:0 nt
    s_waitcnt vmcnt(11)
    buffer_load_dwordx4 v[140:143], v19, s[24:27], s94 offen offset:2048 nt
    s_add_u32 s90, s91, 7
    s_and_b32 s90, s90, 7
    s_lshl_b32 s90, s90, 13
    s_add_u32 s94, s52, s90
    s_waitcnt vmcnt(11)
    buffer_load_dwordx4 v[144:147], v7, s[24:27], s94 offen offset:0 nt
    s_waitcnt vmcnt(11)
    buffer_load_dwordx4 v[148:151], v7, s[24:27], s94 offen offset:2048 nt
    s_waitcnt vmcnt(11)
    buffer_load_dwordx4 v[152:155], v19, s[24:27], s94 offen offset:0 nt
    s_waitcnt vmcnt(11)
    buffer_load_dwordx4 v[156:159], v19, s[24:27], s94 offen offset:2048 nt
    v_mov_b32 v12, 134244
    v_mov_b32 v13, 1
    s_mov_b64 exec, 1
    ds_add_u32 v12, v13
    s_mov_b64 exec, -1
    v_mov_b32 v12, 134232
    s_mov_b32 s57, 0
L_v1p:
    ds_read_b32 v13, v12
    s_waitcnt lgkmcnt(0)
    v_readfirstlane_b32 s59, v13
    s_cmp_eq_u32 s59, 4
    s_cbranch_scc1 L_v1p_ok
    s_sleep 1
    s_add_u32 s57, s57, 1
    s_cmp_lt_u32 s57, 400000
    s_cbranch_scc1 L_v1p
L_v1p_ok:
    s_add_u32 s95, s91, 0
    s_and_b32 s95, s95, 7
    s_lshl_b32 s95, s95, 4
    v_add_u32 v12, s95, v4
    ds_read_b128 v[160:163], v12
    s_waitcnt lgkmcnt(0)
    v_and_b32 v0, v160, v14
    v_and_b32 v1, v160, v15
    v_and_b32 v2, v160, v16
    v_and_b32 v3, v160, v17
    s_add_u32 s95, s91, 1
    s_and_b32 s95, s95, 7
    s_lshl_b32 s95, s95, 4
    v_add_u32 v12, s95, v4
    ds_read_b128 v[164:167], v12
    s_waitcnt vmcnt(31)
    s_nop 0
    v_mfma_f32_16x16x32_bf16 v[20:23], v[0:3], v[32:35], v[20:23]
    v_and_b32 v28, v161, v14
    v_and_b32 v29, v161, v15
    v_and_b32 v30, v161, v16
    v_and_b32 v31, v161, v17
    s_waitcnt vmcnt(30)
    s_nop 0
    v_mfma_f32_16x16x32_bf16 v[20:23], v[28:31], v[36:39], v[20:23]
    v_and_b32 v0, v162, v14
    v_and_b32 v1, v162, v15
    v_and_b32 v2, v162, v16
    v_and_b32 v3, v162, v17
    s_waitcnt vmcnt(29)
    s_nop 0
    v_mfma_f32_16x16x32_bf16 v[20:23], v[0:3], v[40:43], v[20:23]
    v_and_b32 v28, v163, v14
    v_and_b32 v29, v163, v15
    v_and_b32 v30, v163, v16
    v_and_b32 v31, v163, v17
    s_waitcnt vmcnt(28)
    s_waitcnt lgkmcnt(0)
    v_mfma_f32_16x16x32_bf16 v[20:23], v[28:31], v[44:47], v[20:23]
    v_and_b32 v0, v164, v14
    v_and_b32 v1, v164, v15
    v_and_b32 v2, v164, v16
    v_and_b32 v3, v164, v17
    s_add_u32 s95, s91, 2
    s_and_b32 s95, s95, 7
    s_lshl_b32 s95, s95, 4
    v_add_u32 v12, s95, v4
    ds_read_b128 v[160:163], v12
    s_waitcnt vmcnt(27)
    s_nop 0
    v_mfma_f32_16x16x32_bf16 v[20:23], v[0:3], v[48:51], v[20:23]
    v_and_b32 v28, v165, v14
    v_and_b32 v29, v165, v15
    v_and_b32 v30, v165, v16
    v_and_b32 v31, v165, v17
    s_waitcnt vmcnt(26)
    s_nop 0
    v_mfma_f32_16x16x32_bf16 v[20:23], v[28:31], v[52:55], v[20:23]
    v_and_b32 v0, v166, v14
    v_and_b32 v1, v166, v15
    v_and_b32 v2, v166, v16
    v_and_b32 v3, v166, v17
    s_waitcnt vmcnt(25)
    s_nop 0
    v_mfma_f32_16x16x32_bf16 v[20:23], v[0:3], v[56:59], v[20:23]
    v_and_b32 v28, v167, v14
    v_and_b32 v29, v167, v15
    v_and_b32 v30, v167, v16
    v_and_b32 v31, v167, v17
    s_waitcnt vmcnt(24)
    s_waitcnt lgkmcnt(0)
    v_mfma_f32_16x16x32_bf16 v[20:23], v[28:31], v[60:63], v[20:23]
    v_and_b32 v0, v160, v14
    v_and_b32 v1, v160, v15
    v_and_b32 v2, v160, v16
    v_and_b32 v3, v160, v17
    s_add_u32 s95, s91, 3
    s_and_b32 s95, s95, 7
    s_lshl_b32 s95, s95, 4
    v_add_u32 v12, s95, v4
    ds_read_b128 v[164:167], v12
    s_waitcnt vmcnt(23)
    s_nop 0
    v_mfma_f32_16x16x32_bf16 v[20:23], v[0:3], v[64:67], v[20:23]
    v_and_b32 v28, v161, v14
    v_and_b32 v29, v161, v15
    v_and_b32 v30, v161, v16
    v_and_b32 v31, v161, v17
    s_waitcnt vmcnt(22)
    s_nop 0
    v_mfma_f32_16x16x32_bf16 v[20:23], v[28:31], v[68:71], v[20:23]
    v_and_b32 v0, v162, v14
    v_and_b32 v1, v162, v15
    v_and_b32 v2, v162, v16
    v_and_b32 v3, v162, v17
    s_waitcnt vmcnt(21)
    s_nop 0
    v_mfma_f32_16x16x32_bf16 v[20:23], v[0:3], v[72:75], v[20:23]
    v_and_b32 v28, v163, v14
    v_and_b32 v29, v163, v15
    v_and_b32 v30, v163, v16
    v_and_b32 v31, v163, v17
    s_waitcnt vmcnt(20)
    s_waitcnt lgkmcnt(0)
    v_mfma_f32_16x16x32_bf16 v[20:23], v[28:31], v[76:79], v[20:23]
    v_and_b32 v0, v164, v14
    v_and_b32 v1, v164, v15
    v_and_b32 v2, v164, v16
    v_and_b32 v3, v164, v17
    s_add_u32 s95, s91, 4
    s_and_b32 s95, s95, 7
    s_lshl_b32 s95, s95, 4
    v_add_u32 v12, s95, v4
    ds_read_b128 v[160:163], v12
    s_waitcnt vmcnt(19)
    s_nop 0
    v_mfma_f32_16x16x32_bf16 v[20:23], v[0:3], v[80:83], v[20:23]
    v_and_b32 v28, v165, v14
    v_and_b32 v29, v165, v15
    v_and_b32 v30, v165, v16
    v_and_b32 v31, v165, v17
    s_waitcnt vmcnt(18)
    s_nop 0
    v_mfma_f32_16x16x32_bf16 v[20:23], v[28:31], v[84:87], v[20:23]
    v_and_b32 v0, v166, v14
    v_and_b32 v1, v166, v15
    v_and_b32 v2, v166, v16
    v_and_b32 v3, v166, v17
    s_waitcnt vmcnt(17)
    s_nop 0
    v_mfma_f32_16x16x32_bf16 v[20:23], v[0:3], v[88:91], v[20:23]
    v_and_b32 v28, v167, v14
    v_and_b32 v29, v167, v15
    v_and_b32 v30, v167, v16
    v_and_b32 v31, v167, v17
    s_waitcnt vmcnt(16)
    s_waitcnt lgkmcnt(0)
    v_mfma_f32_16x16x32_bf16 v[20:23], v[28:31], v[92:95], v[20:23]
    v_and_b32 v0, v160, v14
    v_and_b32 v1, v160, v15
    v_and_b32 v2, v160, v16
    v_and_b32 v3, v160, v17
    s_add_u32 s95, s91, 5
    s_and_b32 s95, s95, 7
    s_lshl_b32 s95, s95, 4
    v_add_u32 v12, s95, v4
    ds_read_b128 v[164:167], v12
    s_waitcnt vmcnt(15)
    s_nop 0
    v_mfma_f32_16x16x32_bf16 v[20:23], v[0:3], v[96:99], v[20:23]
    v_and_b32 v28, v161, v14
    v_and_b32 v29, v161, v15
    v_and_b32 v30, v161, v16
    v_and_b32 v31, v161, v17
    s_waitcnt vmcnt(14)
    s_nop 0
    v_mfma_f32_16x16x32_bf16 v[20:23], v[28:31], v[100:103], v[20:23]
    v_and_b32 v0, v162, v14
    v_and_b32 v1, v162, v15
    v_and_b32 v2, v162, v16
    v_and_b32 v3, v162, v17
    s_waitcnt vmcnt(13)
    s_nop 0
    v_mfma_f32_16x16x32_bf16 v[20:23], v[0:3], v[104:107], v[20:23]
    v_and_b32 v28, v163, v14
    v_and_b32 v29, v163, v15
    v_and_b32 v30, v163, v16
    v_and_b32 v31, v163, v17
    s_waitcnt vmcnt(12)
    s_waitcnt lgkmcnt(0)
    v_mfma_f32_16x16x32_bf16 v[20:23], v[28:31], v[108:111], v[20:23]
    v_and_b32 v0, v164, v14
    v_and_b32 v1, v164, v15
    v_and_b32 v2, v164, v16
    v_and_b32 v3, v164, v17
    s_add_u32 s95, s91, 6
    s_and_b32 s95, s95, 7
    s_lshl_b32 s95, s95, 4
    v_add_u32 v12, s95, v4
    ds_read_b128 v[160:163], v12
    s_waitcnt vmcnt(11)
    s_nop 0
    v_mfma_f32_16x16x32_bf16 v[20:23], v[0:3], v[112:115], v[20:23]
    v_and_b32 v28, v165, v14
    v_and_b32 v29, v165, v15
    v_and_b32 v30, v165, v16
    v_and_b32 v31, v165, v17
    s_waitcnt vmcnt(10)
    s_nop 0
    v_mfma_f32_16x16x32_bf16 v[20:23], v[28:31], v[116:119], v[20:23]
    v_and_b32 v0, v166, v14
    v_and_b32 v1, v166, v15
    v_and_b32 v2, v166, v16
    v_and_b32 v3, v166, v17
    s_waitcnt vmcnt(9)
    s_nop 0
    v_mfma_f32_16x16x32_bf16 v[20:23], v[0:3], v[120:123], v[20:23]
    v_and_b32 v28, v167, v14
    v_and_b32 v29, v167, v15
    v_and_b32 v30, v167, v16
    v_and_b32 v31, v167, v17
    s_waitcnt vmcnt(8)
    s_waitcnt lgkmcnt(0)
    v_mfma_f32_16x16x32_bf16 v[20:23], v[28:31], v[124:127], v[20:23]
    v_and_b32 v0, v160, v14
    v_and_b32 v1, v160, v15
    v_and_b32 v2, v160, v16
    v_and_b32 v3, v160, v17
    s_add_u32 s95, s91, 7
    s_and_b32 s95, s95, 7
    s_lshl_b32 s95, s95, 4
    v_add_u32 v12, s95, v4
    ds_read_b128 v[164:167], v12
    s_waitcnt vmcnt(7)
    s_nop 0
    v_mfma_f32_16x16x32_bf16 v[20:23], v[0:3], v[128:131], v[20:23]
    v_and_b32 v28, v161, v14
    v_and_b32 v29, v161, v15
    v_and_b32 v30, v161, v16
    v_and_b32 v31, v161, v17
    s_waitcnt vmcnt(6)
    s_nop 0
    v_mfma_f32_16x16x32_bf16 v[20:23], v[28:31], v[132:135], v[20:23]
    v_and_b32 v0, v162, v14
    v_and_b32 v1, v162, v15
    v_and_b32 v2, v162, v16
    v_and_b32 v3, v162, v17
    s_waitcnt vmcnt(5)
    s_nop 0
    v_mfma_f32_16x16x32_bf16 v[20:23], v[0:3], v[136:139], v[20:23]
    v_and_b32 v28, v163, v14
    v_and_b32 v29, v163, v15
    v_and_b32 v30, v163, v16
    v_and_b32 v31, v163, v17
    s_waitcnt vmcnt(4)
    s_waitcnt lgkmcnt(0)
    v_mfma_f32_16x16x32_bf16 v[20:23], v[28:31], v[140:143], v[20:23]
    v_and_b32 v0, v164, v14
    v_and_b32 v1, v164, v15
    v_and_b32 v2, v164, v16
    v_and_b32 v3, v164, v17
    s_waitcnt vmcnt(3)
    s_nop 0
    v_mfma_f32_16x16x32_bf16 v[20:23], v[0:3], v[144:147], v[20:23]
    v_and_b32 v28, v165, v14
    v_and_b32 v29, v165, v15
    v_and_b32 v30, v165, v16
    v_and_b32 v31, v165, v17
    s_waitcnt vmcnt(2)
    s_nop 0
    v_mfma_f32_16x16x32_bf16 v[20:23], v[28:31], v[148:151], v[20:23]
    v_and_b32 v0, v166, v14
    v_and_b32 v1, v166, v15
    v_and_b32 v2, v166, v16
    v_and_b32 v3, v166, v17
    s_waitcnt vmcnt(1)
    s_nop 0
    v_mfma_f32_16x16x32_bf16 v[20:23], v[0:3], v[152:155], v[20:23]
    v_and_b32 v28, v167, v14
    v_and_b32 v29, v167, v15
    v_and_b32 v30, v167, v16
    v_and_b32 v31, v167, v17
    s_waitcnt vmcnt(0)
    s_nop 0
    v_mfma_f32_16x16x32_bf16 v[20:23], v[28:31], v[156:159], v[20:23]
    s_nop 7
    ds_write_b128 v6, v[20:23]
    s_waitcnt lgkmcnt(0)
    v_mov_b32 v12, 134248
    v_mov_b32 v13, 1
    s_mov_b64 exec, 1
    ds_add_u32 v12, v13
    s_mov_b64 exec, -1
    s_mov_b32 s32, s12
    s_and_b32 s33, s13, 0xffff
    s_mov_b32 s34, 3670016
    s_mov_b32 s35, 0x20000
    s_lshl_b32 s52, s58, 4
    s_mul_i32 s52, s52, 896
    s_mul_i32 s3, s53, 7168
    s_add_u32 s52, s52, s3
    s_add_u32 s3, s3, 4096
    v_mov_b32 v7, v6
    s_lshl_b32 s54, s53, 10
    v_subrev_u32 v7, s54, v7
    v_mov_b32 v12, 134236
    s_mov_b32 s57, 0
L_v1w:
    ds_read_b32 v13, v12
    s_waitcnt lgkmcnt(0)
    v_readfirstlane_b32 s59, v13
    s_cmp_ge_u32 s59, 2
    s_cbranch_scc1 L_v1w_ok
    s_sleep 1
    s_add_u32 s57, s57, 1
    s_cmp_lt_u32 s57, 400000
    s_cbranch_scc1 L_v1w
L_v1w_ok:
    s_mov_b32 m0, s3
    s_nop 0
    buffer_load_dwordx4 v7, s[32:35], s52 offen offset:0 nt lds
    buffer_load_dwordx4 v7, s[32:35], s52 offen offset:1024 nt lds
    buffer_load_dwordx4 v7, s[32:35], s52 offen offset:2048 nt lds
    buffer_load_dwordx4 v7, s[32:35], s52 offen offset:3072 nt lds
    s_add_u32 s3, s3, 4096
    s_add_u32 s52, s52, 4096
    s_mov_b32 m0, s3
    s_nop 0
    buffer_load_dwordx4 v7, s[32:35], s52 offen offset:0 nt lds
    buffer_load_dwordx4 v7, s[32:35], s52 offen offset:1024 nt lds
    buffer_load_dwordx4 v7, s[32:35], s52 offen offset:2048 nt lds
    s_waitcnt vmcnt(0)
    v_mov_b32 v12, 134252
    v_mov_b32 v13, 1
    s_mov_b64 exec, 1
    ds_add_u32 v12, v13
    s_mov_b64 exec, -1
    s_endpgm
L_v2:
    v_mov_b32 v12, 134244
    s_mov_b32 s57, 0
L_v2k:
    ds_read_b32 v13, v12
    s_waitcnt lgkmcnt(0)
    v_readfirstlane_b32 s59, v13
    s_cmp_ge_u32 s59, 1
    s_cbranch_scc1 L_v2k_ok
    s_sleep 1
    s_add_u32 s57, s57, 1
    s_cmp_lt_u32 s57, 400000
    s_cbranch_scc1 L_v2k
L_v2k_ok:
    s_add_u32 s90, s91, 0
    s_and_b32 s90, s90, 7
    s_lshl_b32 s90, s90, 13
    s_add_u32 s94, s52, s90
    buffer_load_dwordx4 v[32:35], v7, s[24:27], s94 offen offset:0 nt
    buffer_load_dwordx4 v[36:39], v7, s[24:27], s94 offen offset:2048 nt
    buffer_load_dwordx4 v[40:43], v19, s[24:27], s94 offen offset:0 nt
    buffer_load_dwordx4 v[44:47], v19, s[24:27], s94 offen offset:2048 nt
    s_add_u32 s90, s91, 1
    s_and_b32 s90, s90, 7
    s_lshl_b32 s90, s90, 13
    s_add_u32 s94, s52, s90
    buffer_load_dwordx4 v[48:51], v7, s[24:27], s94 offen offset:0 nt
    buffer_load_dwordx4 v[52:55], v7, s[24:27], s94 offen offset:2048 nt
    buffer_load_dwordx4 v[56:59], v19, s[24:27], s94 offen offset:0 nt
    buffer_load_dwordx4 v[60:63], v19, s[24:27], s94 offen offset:2048 nt
    s_add_u32 s90, s91, 2
    s_and_b32 s90, s90, 7
    s_lshl_b32 s90, s90, 13
    s_add_u32 s94, s52, s90
    buffer_load_dwordx4 v[64:67], v7, s[24:27], s94 offen offset:0 nt
    buffer_load_dwordx4 v[68:71], v7, s[24:27], s94 offen offset:2048 nt
    buffer_load_dwordx4 v[72:75], v19, s[24:27], s94 offen offset:0 nt
    buffer_load_dwordx4 v[76:79], v19, s[24:27], s94 offen offset:2048 nt
    s_add_u32 s90, s91, 3
    s_and_b32 s90, s90, 7
    s_lshl_b32 s90, s90, 13
    s_add_u32 s94, s52, s90
    s_waitcnt vmcnt(11)
    buffer_load_dwordx4 v[80:83], v7, s[24:27], s94 offen offset:0 nt
    s_waitcnt vmcnt(11)
    buffer_load_dwordx4 v[84:87], v7, s[24:27], s94 offen offset:2048 nt
    s_waitcnt vmcnt(11)
    buffer_load_dwordx4 v[88:91], v19, s[24:27], s94 offen offset:0 nt
    s_waitcnt vmcnt(11)
    buffer_load_dwordx4 v[92:95], v19, s[24:27], s94 offen offset:2048 nt
    s_add_u32 s90, s91, 4
    s_and_b32 s90, s90, 7
    s_lshl_b32 s90, s90, 13
    s_add_u32 s94, s52, s90
    s_waitcnt vmcnt(11)
    buffer_load_dwordx4 v[96:99], v7, s[24:27], s94 offen offset:0 nt
    s_waitcnt vmcnt(11)
    buffer_load_dwordx4 v[100:103], v7, s[24:27], s94 offen offset:2048 nt
    s_waitcnt vmcnt(11)
    buffer_load_dwordx4 v[104:107], v19, s[24:27], s94 offen offset:0 nt
    s_waitcnt vmcnt(11)
    buffer_load_dwordx4 v[108:111], v19, s[24:27], s94 offen offset:2048 nt
    s_add_u32 s90, s91, 5
    s_and_b32 s90, s90, 7
    s_lshl_b32 s90, s90, 13
    s_add_u32 s94, s52, s90
    s_waitcnt vmcnt(11)
    buffer_load_dwordx4 v[112:115], v7, s[24:27], s94 offen offset:0 nt
    s_waitcnt vmcnt(11)
    buffer_load_dwordx4 v[116:119], v7, s[24:27], s94 offen offset:2048 nt
    s_waitcnt vmcnt(11)
    buffer_load_dwordx4 v[120:123], v19, s[24:27], s94 offen offset:0 nt
    s_waitcnt vmcnt(11)
    buffer_load_dwordx4 v[124:127], v19, s[24:27], s94 offen offset:2048 nt
    v_mov_b32 v12, 134232
    s_mov_b32 s57, 0
L_v2p:
    ds_read_b32 v13, v12
    s_waitcnt lgkmcnt(0)
    v_readfirstlane_b32 s59, v13
    s_cmp_eq_u32 s59, 4
    s_cbranch_scc1 L_v2p_ok
    s_sleep 1
    s_add_u32 s57, s57, 1
    s_cmp_lt_u32 s57, 400000
    s_cbranch_scc1 L_v2p
L_v2p_ok:
    ds_read_b128 v[160:163], v9
    ds_read_b32 v24, v10
    s_waitcnt lgkmcnt(0)
    v_add_f32 v160, v160, v161
    v_add_f32 v162, v162, v163
    v_add_f32 v25, v160, v162
    v_mov_b32 v26, v24
    v_mov_b32 v27, v24
    v_bfi_b32 v24, v18, v24, s51
    v_bfi_b32 v25, v18, v25, s51
    v_bfi_b32 v26, v18, v26, s51
    v_bfi_b32 v27, v18, v27, s51
    buffer_store_dwordx4 v[24:27], v5, s[36:39], s55 offen offset:64
    s_add_u32 s3, s55, s97
    s_add_u32 s95, s91, 0
    s_and_b32 s95, s95, 7
    s_lshl_b32 s95, s95, 4
    v_add_u32 v12, s95, v4
    ds_read_b128 v[160:163], v12
    s_waitcnt lgkmcnt(0)
    v_and_b32 v0, v160, v14
    v_and_b32 v1, v160, v15
    v_and_b32 v2, v160, v16
    v_and_b32 v3, v160, v17
    s_add_u32 s90, s91, 6
    s_and_b32 s90, s90, 7
    s_lshl_b32 s90, s90, 13
    s_add_u32 s94, s52, s90
    s_waitcnt vmcnt(12)
    buffer_load_dwordx4 v[128:131], v7, s[24:27], s94 offen offset:0 nt
    s_add_u32 s95, s91, 1
    s_and_b32 s95, s95, 7
    s_lshl_b32 s95, s95, 4
    v_add_u32 v12, s95, v4
    ds_read_b128 v[164:167], v12
    s_waitcnt vmcnt(25)
    s_nop 0
    v_mfma_f32_16x16x32_bf16 v[20:23], v[0:3], v[32:35], v[20:23]
    v_and_b32 v28, v161, v14
    v_and_b32 v29, v161, v15
    v_and_b32 v30, v161, v16
    v_and_b32 v31, v161, v17
    s_waitcnt vmcnt(24)
    s_nop 0
    v_mfma_f32_16x16x32_bf16 v[20:23], v[28:31], v[36:39], v[20:23]
    v_and_b32 v0, v162, v14
    v_and_b32 v1, v162, v15
    v_and_b32 v2, v162, v16
    v_and_b32 v3, v162, v17
    s_waitcnt vmcnt(23)
    s_nop 0
    v_mfma_f32_16x16x32_bf16 v[20:23], v[0:3], v[40:43], v[20:23]
    v_and_b32 v28, v163, v14
    v_and_b32 v29, v163, v15
    v_and_b32 v30, v163, v16
    v_and_b32 v31, v163, v17
    s_waitcnt vmcnt(12)
    buffer_load_dwordx4 v[132:135], v7, s[24:27], s94 offen offset:2048 nt
    s_waitcnt vmcnt(23)
    s_waitcnt lgkmcnt(0)
    v_mfma_f32_16x16x32_bf16 v[20:23], v[28:31], v[44:47], v[20:23]
    v_and_b32 v0, v164, v14
    v_and_b32 v1, v164, v15
    v_and_b32 v2, v164, v16
    v_and_b32 v3, v164, v17
    s_add_u32 s95, s91, 2
    s_and_b32 s95, s95, 7
    s_lshl_b32 s95, s95, 4
    v_add_u32 v12, s95, v4
    ds_read_b128 v[160:163], v12
    s_waitcnt vmcnt(22)
    s_nop 0
    v_mfma_f32_16x16x32_bf16 v[20:23], v[0:3], v[48:51], v[20:23]
    v_and_b32 v28, v165, v14
    v_and_b32 v29, v165, v15
    v_and_b32 v30, v165, v16
    v_and_b32 v31, v165, v17
    s_waitcnt vmcnt(21)
    s_nop 0
    v_mfma_f32_16x16x32_bf16 v[20:23], v[28:31], v[52:55], v[20:23]
    v_and_b32 v0, v166, v14
    v_and_b32 v1, v166, v15
    v_and_b32 v2, v166, v16
    v_and_b32 v3, v166, v17
    s_waitcnt vmcnt(12)
    buffer_load_dwordx4 v[136:139], v19, s[24:27], s94 offen offset:0 nt
    s_waitcnt vmcnt(21)
    s_nop 0
    v_mfma_f32_16x16x32_bf16 v[20:23], v[0:3], v[56:59], v[20:23]
    v_and_b32 v28, v167, v14
    v_and_b32 v29, v167, v15
    v_and_b32 v30, v167, v16
    v_and_b32 v31, v167, v17
    s_waitcnt vmcnt(20)
    s_waitcnt lgkmcnt(0)
    v_mfma_f32_16x16x32_bf16 v[20:23], v[28:31], v[60:63], v[20:23]
    v_and_b32 v0, v160, v14
    v_and_b32 v1, v160, v15
    v_and_b32 v2, v160, v16
    v_and_b32 v3, v160, v17
    s_add_u32 s95, s91, 3
    s_and_b32 s95, s95, 7
    s_lshl_b32 s95, s95, 4
    v_add_u32 v12, s95, v4
    ds_read_b128 v[164:167], v12
    s_waitcnt vmcnt(19)
    s_nop 0
    v_mfma_f32_16x16x32_bf16 v[20:23], v[0:3], v[64:67], v[20:23]
    v_and_b32 v28, v161, v14
    v_and_b32 v29, v161, v15
    v_and_b32 v30, v161, v16
    v_and_b32 v31, v161, v17
    s_waitcnt vmcnt(12)
    buffer_load_dwordx4 v[140:143], v19, s[24:27], s94 offen offset:2048 nt
    s_waitcnt vmcnt(19)
    s_nop 0
    v_mfma_f32_16x16x32_bf16 v[20:23], v[28:31], v[68:71], v[20:23]
    v_and_b32 v0, v162, v14
    v_and_b32 v1, v162, v15
    v_and_b32 v2, v162, v16
    v_and_b32 v3, v162, v17
    s_waitcnt vmcnt(18)
    s_nop 0
    v_mfma_f32_16x16x32_bf16 v[20:23], v[0:3], v[72:75], v[20:23]
    v_and_b32 v28, v163, v14
    v_and_b32 v29, v163, v15
    v_and_b32 v30, v163, v16
    v_and_b32 v31, v163, v17
    s_waitcnt vmcnt(17)
    s_waitcnt lgkmcnt(0)
    v_mfma_f32_16x16x32_bf16 v[20:23], v[28:31], v[76:79], v[20:23]
    v_and_b32 v0, v164, v14
    v_and_b32 v1, v164, v15
    v_and_b32 v2, v164, v16
    v_and_b32 v3, v164, v17
    s_add_u32 s90, s91, 7
    s_and_b32 s90, s90, 7
    s_lshl_b32 s90, s90, 13
    s_add_u32 s94, s52, s90
    s_waitcnt vmcnt(12)
    buffer_load_dwordx4 v[144:147], v7, s[24:27], s94 offen offset:0 nt
    s_add_u32 s95, s91, 4
    s_and_b32 s95, s95, 7
    s_lshl_b32 s95, s95, 4
    v_add_u32 v12, s95, v4
    ds_read_b128 v[160:163], v12
    s_waitcnt vmcnt(17)
    s_nop 0
    v_mfma_f32_16x16x32_bf16 v[20:23], v[0:3], v[80:83], v[20:23]
    v_and_b32 v28, v165, v14
    v_and_b32 v29, v165, v15
    v_and_b32 v30, v165, v16
    v_and_b32 v31, v165, v17
    s_waitcnt vmcnt(16)
    s_nop 0
    v_mfma_f32_16x16x32_bf16 v[20:23], v[28:31], v[84:87], v[20:23]
    v_and_b32 v0, v166, v14
    v_and_b32 v1, v166, v15
    v_and_b32 v2, v166, v16
    v_and_b32 v3, v166, v17
    s_waitcnt vmcnt(15)
    s_nop 0
    v_mfma_f32_16x16x32_bf16 v[20:23], v[0:3], v[88:91], v[20:23]
    v_and_b32 v28, v167, v14
    v_and_b32 v29, v167, v15
    v_and_b32 v30, v167, v16
    v_and_b32 v31, v167, v17
    s_waitcnt vmcnt(12)
    buffer_load_dwordx4 v[148:151], v7, s[24:27], s94 offen offset:2048 nt
    s_waitcnt vmcnt(15)
    s_waitcnt lgkmcnt(0)
    v_mfma_f32_16x16x32_bf16 v[20:23], v[28:31], v[92:95], v[20:23]
    v_and_b32 v0, v160, v14
    v_and_b32 v1, v160, v15
    v_and_b32 v2, v160, v16
    v_and_b32 v3, v160, v17
    s_add_u32 s95, s91, 5
    s_and_b32 s95, s95, 7
    s_lshl_b32 s95, s95, 4
    v_add_u32 v12, s95, v4
    ds_read_b128 v[164:167], v12
    s_waitcnt vmcnt(14)
    s_nop 0
    v_mfma_f32_16x16x32_bf16 v[20:23], v[0:3], v[96:99], v[20:23]
    v_and_b32 v28, v161, v14
    v_and_b32 v29, v161, v15
    v_and_b32 v30, v161, v16
    v_and_b32 v31, v161, v17
    s_waitcnt vmcnt(13)
    s_nop 0
    v_mfma_f32_16x16x32_bf16 v[20:23], v[28:31], v[100:103], v[20:23]
    v_and_b32 v0, v162, v14
    v_and_b32 v1, v162, v15
    v_and_b32 v2, v162, v16
    v_and_b32 v3, v162, v17
    s_waitcnt vmcnt(12)
    buffer_load_dwordx4 v[152:155], v19, s[24:27], s94 offen offset:0 nt
    s_waitcnt vmcnt(13)
    s_nop 0
    v_mfma_f32_16x16x32_bf16 v[20:23], v[0:3], v[104:107], v[20:23]
    v_and_b32 v28, v163, v14
    v_and_b32 v29, v163, v15
    v_and_b32 v30, v163, v16
    v_and_b32 v31, v163, v17
    s_waitcnt vmcnt(12)
    s_waitcnt lgkmcnt(0)
    v_mfma_f32_16x16x32_bf16 v[20:23], v[28:31], v[108:111], v[20:23]
    v_and_b32 v0, v164, v14
    v_and_b32 v1, v164, v15
    v_and_b32 v2, v164, v16
    v_and_b32 v3, v164, v17
    s_add_u32 s95, s91, 6
    s_and_b32 s95, s95, 7
    s_lshl_b32 s95, s95, 4
    v_add_u32 v12, s95, v4
    ds_read_b128 v[160:163], v12
    s_waitcnt vmcnt(11)
    s_nop 0
    v_mfma_f32_16x16x32_bf16 v[20:23], v[0:3], v[112:115], v[20:23]
    v_and_b32 v28, v165, v14
    v_and_b32 v29, v165, v15
    v_and_b32 v30, v165, v16
    v_and_b32 v31, v165, v17
    s_waitcnt vmcnt(12)
    buffer_load_dwordx4 v[156:159], v19, s[24:27], s94 offen offset:2048 nt
    s_waitcnt vmcnt(11)
    s_nop 0
    v_mfma_f32_16x16x32_bf16 v[20:23], v[28:31], v[116:119], v[20:23]
    v_and_b32 v0, v166, v14
    v_and_b32 v1, v166, v15
    v_and_b32 v2, v166, v16
    v_and_b32 v3, v166, v17
    s_waitcnt vmcnt(10)
    s_nop 0
    v_mfma_f32_16x16x32_bf16 v[20:23], v[0:3], v[120:123], v[20:23]
    v_and_b32 v28, v167, v14
    v_and_b32 v29, v167, v15
    v_and_b32 v30, v167, v16
    v_and_b32 v31, v167, v17
    s_waitcnt vmcnt(9)
    s_waitcnt lgkmcnt(0)
    v_mfma_f32_16x16x32_bf16 v[20:23], v[28:31], v[124:127], v[20:23]
    v_and_b32 v0, v160, v14
    v_and_b32 v1, v160, v15
    v_and_b32 v2, v160, v16
    v_and_b32 v3, v160, v17
    v_mov_b32 v12, 134236
    v_mov_b32 v13, 1
    s_mov_b64 exec, 1
    ds_add_u32 v12, v13
    s_mov_b64 exec, -1
    v_mov_b32 v12, 134248
    s_mov_b32 s57, 0
L_v2r:
    ds_read_b32 v13, v12
    s_waitcnt lgkmcnt(0)
    v_readfirstlane_b32 s59, v13
    s_cmp_eq_u32 s59, 2
    s_cbranch_scc1 L_v2r_ok
    s_add_u32 s57, s57, 1
    s_cmp_lt_u32 s57, 400000
    s_cbranch_scc1 L_v2r
L_v2r_ok:
    ds_read_b128 v[8:11], v6
    s_add_u32 s95, s91, 7
    s_and_b32 s95, s95, 7
    s_lshl_b32 s95, s95, 4
    v_add_u32 v12, s95, v4
    ds_read_b128 v[164:167], v12
    s_waitcnt vmcnt(7)
    s_nop 0
    v_mfma_f32_16x16x32_bf16 v[20:23], v[0:3], v[128:131], v[20:23]
    v_and_b32 v28, v161, v14
    v_and_b32 v29, v161, v15
    v_and_b32 v30, v161, v16
    v_and_b32 v31, v161, v17
    s_waitcnt vmcnt(6)
    s_nop 0
    v_mfma_f32_16x16x32_bf16 v[20:23], v[28:31], v[132:135], v[20:23]
    v_and_b32 v0, v162, v14
    v_and_b32 v1, v162, v15
    v_and_b32 v2, v162, v16
    v_and_b32 v3, v162, v17
    s_waitcnt vmcnt(5)
    s_nop 0
    v_mfma_f32_16x16x32_bf16 v[20:23], v[0:3], v[136:139], v[20:23]
    v_and_b32 v28, v163, v14
    v_and_b32 v29, v163, v15
    v_and_b32 v30, v163, v16
    v_and_b32 v31, v163, v17
    s_waitcnt vmcnt(4)
    s_waitcnt lgkmcnt(0)
    v_mfma_f32_16x16x32_bf16 v[20:23], v[28:31], v[140:143], v[20:23]
    v_and_b32 v0, v164, v14
    v_and_b32 v1, v164, v15
    v_and_b32 v2, v164, v16
    v_and_b32 v3, v164, v17
    s_waitcnt vmcnt(3)
    s_nop 0
    v_mfma_f32_16x16x32_bf16 v[20:23], v[0:3], v[144:147], v[20:23]
    v_and_b32 v28, v165, v14
    v_and_b32 v29, v165, v15
    v_and_b32 v30, v165, v16
    v_and_b32 v31, v165, v17
    s_waitcnt vmcnt(2)
    s_nop 0
    v_mfma_f32_16x16x32_bf16 v[20:23], v[28:31], v[148:151], v[20:23]
    v_and_b32 v0, v166, v14
    v_and_b32 v1, v166, v15
    v_and_b32 v2, v166, v16
    v_and_b32 v3, v166, v17
    s_waitcnt vmcnt(1)
    s_nop 0
    v_mfma_f32_16x16x32_bf16 v[20:23], v[0:3], v[152:155], v[20:23]
    v_and_b32 v28, v167, v14
    v_and_b32 v29, v167, v15
    v_and_b32 v30, v167, v16
    v_and_b32 v31, v167, v17
    s_waitcnt vmcnt(0)
    s_nop 0
    v_mfma_f32_16x16x32_bf16 v[20:23], v[28:31], v[156:159], v[20:23]
    s_waitcnt lgkmcnt(0)
    s_nop 6
    v_add_f32 v20, v20, v8
    v_add_f32 v21, v21, v9
    v_add_f32 v22, v22, v10
    v_add_f32 v23, v23, v11
    v_bfi_b32 v20, v18, v20, s51
    v_bfi_b32 v21, v18, v21, s51
    v_bfi_b32 v22, v18, v22, s51
    v_bfi_b32 v23, v18, v23, s51
    buffer_store_dwordx4 v[20:23], v5, s[36:39], s55 offen
    v_mov_b32 v12, 134256
    s_mov_b32 s57, 0
L_v2c:
    ds_read_b32 v13, v12
    s_waitcnt lgkmcnt(0)
    v_readfirstlane_b32 s59, v13
    s_cmp_ge_u32 s59, 1
    s_cbranch_scc1 L_v2c_ok
    s_sleep 4
    s_add_u32 s57, s57, 1
    s_cmp_lt_u32 s57, 40
    s_cbranch_scc1 L_v2c
L_v2c_ok:
    buffer_store_dwordx4 v[20:23], v5, s[36:39], s3 offen sc1
    buffer_store_dwordx4 v[24:27], v5, s[36:39], s3 offen offset:64 sc1
    s_endpgm
L_comm:
    s_setprio 3
    v_mov_b32 v12, 134224
    v_mov_b32 v20, 0
    v_mov_b32 v21, 0
    v_mov_b32 v22, 0
    v_mov_b32 v23, 0
    ds_write_b128 v12, v[20:23]
    ds_write_b128 v12, v[20:23] offset:16
    ds_write_b128 v12, v[20:23] offset:32
    s_waitcnt lgkmcnt(0)
    s_barrier
    v_lshlrev_b32 v6, 15, v3
    v_lshl_add_u32 v6, v2, 4, v6
    v_lshlrev_b32 v7, 3, v3
    s_lshl_b32 s52, s49, 17
    s_lshl_b32 s53, s48, 10
    s_add_u32 s52, s52, s53
    s_lshl_b32 s54, s49, 5
    v_lshlrev_b32 v4, 4, v0
    s_waitcnt lgkmcnt(0)
    s_mov_b32 s40, s4
    s_and_b32 s41, s5, 0xffff
    s_mov_b32 s42, 896
    s_mov_b32 s43, 0x20000
    s_mov_b32 s28, s10
    s_and_b32 s29, s11, 0xffff
    s_mov_b32 s30, 3670016
    s_mov_b32 s31, 0x20000
    buffer_load_dwordx2 v[28:29], v7, s[40:43], s54 offen
    s_load_dword s51, s[18:19], 0
    buffer_load_dwordx4 v[64:67], v6, s[28:31], s52 offen offset:0 nt
    buffer_load_dwordx4 v[68:71], v6, s[28:31], s52 offen offset:256 nt
    buffer_load_dwordx4 v[72:75], v6, s[28:31], s52 offen offset:512 nt
    buffer_load_dwordx4 v[76:79], v6, s[28:31], s52 offen offset:768 nt
    s_add_u32 s52, s52, 8192
    buffer_load_dwordx4 v[80:83], v6, s[28:31], s52 offen offset:0 nt
    buffer_load_dwordx4 v[84:87], v6, s[28:31], s52 offen offset:256 nt
    buffer_load_dwordx4 v[88:91], v6, s[28:31], s52 offen offset:512 nt
    buffer_load_dwordx4 v[92:95], v6, s[28:31], s52 offen offset:768 nt
    s_add_u32 s52, s52, 8192
    buffer_load_dwordx4 v[96:99], v6, s[28:31], s52 offen offset:0 nt
    buffer_load_dwordx4 v[100:103], v6, s[28:31], s52 offen offset:256 nt
    buffer_load_dwordx4 v[104:107], v6, s[28:31], s52 offen offset:512 nt
    buffer_load_dwordx4 v[108:111], v6, s[28:31], s52 offen offset:768 nt
    s_add_u32 s52, s52, 8192
    buffer_load_dwordx4 v[112:115], v6, s[28:31], s52 offen offset:0 nt
    buffer_load_dwordx4 v[116:119], v6, s[28:31], s52 offen offset:256 nt
    buffer_load_dwordx4 v[120:123], v6, s[28:31], s52 offen offset:512 nt
    buffer_load_dwordx4 v[124:127], v6, s[28:31], s52 offen offset:768 nt
    s_mov_b32 s36, s18
    s_and_b32 s37, s19, 0xffff
    s_mov_b32 s38, 268435456
    s_mov_b32 s39, 0x20000
    s_lshl_b32 s52, s48, 16
    s_lshl_b32 s53, s49, 6
    s_add_u32 s96, s53, s52
    s_lshl_b32 s54, s49, 11
    s_add_u32 s52, s52, s54
    s_add_u32 s92, s52, 524288
    s_add_u32 s93, s52, 1048576
    buffer_load_dwordx4 v[128:131], v4, s[36:39], s92 offen offset:0 sc1
    buffer_load_dwordx4 v[132:135], v4, s[36:39], s92 offen offset:1024 sc1
    buffer_load_dwordx4 v[136:139], v4, s[36:39], s93 offen offset:0 sc1
    buffer_load_dwordx4 v[140:143], v4, s[36:39], s93 offen offset:1024 sc1
    s_mov_b32 s44, s14
    s_and_b32 s45, s15, 0xffff
    s_mov_b32 s46, 896
    s_mov_b32 s47, 0x20000
    v_and_b32 v18, 1, v0
    v_lshlrev_b32 v18, 4, v18
    v_mov_b32 v19, 0xffff
    v_lshlrev_b32 v19, v18, v19
    v_bfe_u32 v18, v0, 1, 2
    v_cmp_eq_u32 vcc, 0, v18
    s_nop 1
    v_cndmask_b32 v14, 0, v19, vcc
    v_cmp_eq_u32 vcc, 1, v18
    s_nop 1
    v_cndmask_b32 v15, 0, v19, vcc
    v_cmp_eq_u32 vcc, 2, v18
    s_nop 1
    v_cndmask_b32 v16, 0, v19, vcc
    v_cmp_eq_u32 vcc, 3, v18
    s_nop 1
    v_cndmask_b32 v17, 0, v19, vcc
    v_mov_b32 v18, 0xffffff00
    v_mov_b32 v48, 0
    v_mov_b32 v49, 0
    v_mov_b32 v50, 0
    v_mov_b32 v51, 0
    v_mov_b32 v52, 0
    v_mov_b32 v53, 0
    v_mov_b32 v54, 0
    v_mov_b32 v55, 0
    v_mov_b32 v56, 0
    v_mov_b32 v57, 0
    v_mov_b32 v58, 0
    v_mov_b32 v59, 0
    v_mov_b32 v60, 0
    v_mov_b32 v61, 0
    v_mov_b32 v62, 0
    v_mov_b32 v63, 0
    v_lshrrev_b32 v1, 1, v2
    v_lshlrev_b32 v1, 11, v1
    v_and_b32 v10, 1, v2
    v_lshl_add_u32 v1, v10, 5, v1
    v_lshl_add_u32 v1, v3, 4, v1
    v_lshrrev_b32 v9, 2, v0
    v_lshlrev_b32 v9, 11, v9
    v_and_b32 v10, 3, v0
    v_lshl_add_u32 v9, v10, 4, v9
    v_mov_b32 v10, 0xffff0000
    v_lshlrev_b32 v5, 3, v0
    v_add_u32 v5, 133120, v5
    s_mov_b32 s4, 0x01000100
    s_mov_b32 s5, 0x03020302
    s_waitcnt vmcnt(20) lgkmcnt(0)
    s_add_u32 s51, s51, 1
    s_and_b32 s59, s51, 0xff
    s_cmp_eq_u32 s59, 0
    s_addc_u32 s51, s51, 0
    s_bfe_u32 s97, s51, 0x40008
    s_lshl_b32 s97, s97, 22
    s_add_u32 s97, s97, 8388608
    s_and_b32 s3, s51, 0xff
    v_mov_b32 v19, s3
    v_mov_b32 v7, v9
    v_perm_b32 v20, v28, v28, s4
    v_perm_b32 v21, v28, v28, s5
    v_perm_b32 v22, v29, v29, s4
    v_perm_b32 v23, v29, v29, s5
    v_and_b32 v32, v20, v14
    v_and_b32 v33, v20, v15
    v_and_b32 v34, v20, v16
    v_and_b32 v35, v20, v17
    v_and_b32 v36, v21, v14
    v_and_b32 v37, v21, v15
    v_and_b32 v38, v21, v16
    v_and_b32 v39, v21, v17
    v_and_b32 v40, v22, v14
    v_and_b32 v41, v22, v15
    v_and_b32 v42, v22, v16
    v_and_b32 v43, v22, v17
    v_and_b32 v44, v23, v14
    v_and_b32 v45, v23, v15
    v_and_b32 v46, v23, v16
    v_and_b32 v47, v23, v17
    s_waitcnt vmcnt(16)
    v_mfma_f32_16x16x32_bf16 v[48:51], v[32:35], v[64:67], v[48:51]
    v_mfma_f32_16x16x32_bf16 v[52:55], v[32:35], v[68:71], v[52:55]
    v_mfma_f32_16x16x32_bf16 v[56:59], v[32:35], v[72:75], v[56:59]
    v_mfma_f32_16x16x32_bf16 v[60:63], v[32:35], v[76:79], v[60:63]
    s_waitcnt vmcnt(12)
    v_mfma_f32_16x16x32_bf16 v[48:51], v[36:39], v[80:83], v[48:51]
    v_mfma_f32_16x16x32_bf16 v[52:55], v[36:39], v[84:87], v[52:55]
    v_mfma_f32_16x16x32_bf16 v[56:59], v[36:39], v[88:91], v[56:59]
    v_mfma_f32_16x16x32_bf16 v[60:63], v[36:39], v[92:95], v[60:63]
    s_waitcnt vmcnt(8)
    v_mfma_f32_16x16x32_bf16 v[48:51], v[40:43], v[96:99], v[48:51]
    v_mfma_f32_16x16x32_bf16 v[52:55], v[40:43], v[100:103], v[52:55]
    v_mfma_f32_16x16x32_bf16 v[56:59], v[40:43], v[104:107], v[56:59]
    v_mfma_f32_16x16x32_bf16 v[60:63], v[40:43], v[108:111], v[60:63]
    s_waitcnt vmcnt(4)
    v_mfma_f32_16x16x32_bf16 v[48:51], v[44:47], v[112:115], v[48:51]
    v_mfma_f32_16x16x32_bf16 v[52:55], v[44:47], v[116:119], v[52:55]
    v_mfma_f32_16x16x32_bf16 v[56:59], v[44:47], v[120:123], v[56:59]
    v_mfma_f32_16x16x32_bf16 v[60:63], v[44:47], v[124:127], v[60:63]
    s_add_u32 s59, s96, 524288
    s_mov_b32 exec_hi, 0
    s_waitcnt vmcnt(0)
    s_nop 3
    v_bfi_b32 v48, v18, v48, s51
    v_bfi_b32 v49, v18, v49, s51
    v_bfi_b32 v50, v18, v50, s51
    v_bfi_b32 v51, v18, v51, s51
    buffer_store_dwordx4 v[48:51], v1, s[36:39], s59 offen
    s_add_u32 s59, s59, 16384
    v_bfi_b32 v52, v18, v52, s51
    v_bfi_b32 v53, v18, v53, s51
    v_bfi_b32 v54, v18, v54, s51
    v_bfi_b32 v55, v18, v55, s51
    buffer_store_dwordx4 v[52:55], v1, s[36:39], s59 offen
    s_add_u32 s59, s59, 16384
    v_bfi_b32 v56, v18, v56, s51
    v_bfi_b32 v57, v18, v57, s51
    v_bfi_b32 v58, v18, v58, s51
    v_bfi_b32 v59, v18, v59, s51
    buffer_store_dwordx4 v[56:59], v1, s[36:39], s59 offen
    s_add_u32 s59, s59, 16384
    v_bfi_b32 v60, v18, v60, s51
    v_bfi_b32 v61, v18, v61, s51
    v_bfi_b32 v62, v18, v62, s51
    v_bfi_b32 v63, v18, v63, s51
    buffer_store_dwordx4 v[60:63], v1, s[36:39], s59 offen
    s_mov_b64 exec, -1
    s_mov_b32 s57, 0
    s_branch L_pa_ld
L_pa:
    s_sleep 2
    s_add_u32 s57, s57, 1
    s_cmp_ge_u32 s57, 48
    s_cbranch_scc1 L_pa_slow
L_pa_ld:
    buffer_load_dwordx4 v[64:67], v4, s[36:39], s92 offen sc1
    buffer_load_dwordx4 v[68:71], v4, s[36:39], s92 offen offset:1024 sc1
    buffer_load_dwordx4 v[136:139], v4, s[36:39], s93 offen sc1
    buffer_load_dwordx4 v[140:143], v4, s[36:39], s93 offen offset:1024 sc1
    s_waitcnt vmcnt(0)
    v_msad_u8 v12, v64, v19, 0
    v_msad_u8 v13, v65, v19, 0
    v_msad_u8 v12, v66, v19, v12
    v_msad_u8 v13, v67, v19, v13
    v_msad_u8 v12, v68, v19, v12
    v_msad_u8 v13, v69, v19, v13
    v_msad_u8 v12, v70, v19, v12
    v_msad_u8 v13, v71, v19, v13
    v_or_b32 v12, v12, v13
    v_cmp_ne_u32 vcc, 0, v12
    s_cbranch_vccnz L_pa
    s_branch L_pa_done
L_pa_slow:
    s_and_b32 s91, s57, 15
    s_cmp_eq_u32 s91, 0
    s_cbranch_scc0 L_pa_nf
    s_mov_b32 exec_hi, 0
    s_add_u32 s59, s96, s97
    s_add_u32 s91, s59, 524288
    buffer_store_dwordx4 v[48:51], v1, s[36:39], s91 offen sc1
    s_add_u32 s91, s91, 16384
    buffer_store_dwordx4 v[52:55], v1, s[36:39], s91 offen sc1
    s_add_u32 s91, s91, 16384
    buffer_store_dwordx4 v[56:59], v1, s[36:39], s91 offen sc1
    s_add_u32 s91, s91, 16384
    buffer_store_dwordx4 v[60:63], v1, s[36:39], s91 offen sc1
    s_mov_b64 exec, -1
L_pa_nf:
    s_mov_b32 s90, s92
    s_bitcmp1_b32 s57, 0
    s_cbranch_scc0 L_pa_c1
    s_add_u32 s90, s92, s97
L_pa_c1:
    buffer_load_dwordx4 v[64:67], v4, s[36:39], s90 offen sc1
    buffer_load_dwordx4 v[68:71], v4, s[36:39], s90 offen offset:1024 sc1
    buffer_load_dwordx4 v[136:139], v4, s[36:39], s93 offen sc1
    buffer_load_dwordx4 v[140:143], v4, s[36:39], s93 offen offset:1024 sc1
    s_waitcnt vmcnt(0)
    v_msad_u8 v12, v64, v19, 0
    v_msad_u8 v13, v65, v19, 0
    v_msad_u8 v12, v66, v19, v12
    v_msad_u8 v13, v67, v19, v13
    v_msad_u8 v12, v68, v19, v12
    v_msad_u8 v13, v69, v19, v13
    v_msad_u8 v12, v70, v19, v12
    v_msad_u8 v13, v71, v19, v13
    v_or_b32 v12, v12, v13
    v_cmp_ne_u32 vcc, 0, v12
    s_cbranch_vccz L_pa_done
    s_sleep 2
    s_add_u32 s57, s57, 1
    s_cmp_lt_u32 s57, 20000
    s_cbranch_scc1 L_pa_slow
L_pa_done:
    v_add_f32 v20, v64, v68
    v_add_f32 v21, v65, v69
    v_add_f32 v22, v66, v70
    v_add_f32 v23, v67, v71
    v_add_f32_dpp v20, v20, v20 row_ror:4 row_mask:0xf bank_mask:0xf
    v_add_f32_dpp v21, v21, v21 row_ror:4 row_mask:0xf bank_mask:0xf
    v_add_f32_dpp v22, v22, v22 row_ror:4 row_mask:0xf bank_mask:0xf
    v_add_f32_dpp v23, v23, v23 row_ror:4 row_mask:0xf bank_mask:0xf
    v_add_f32_dpp v20, v20, v20 row_ror:8 row_mask:0xf bank_mask:0xf
    v_add_f32_dpp v21, v21, v21 row_ror:8 row_mask:0xf bank_mask:0xf
    v_add_f32_dpp v22, v22, v22 row_ror:8 row_mask:0xf bank_mask:0xf
    v_add_f32_dpp v23, v23, v23 row_ror:8 row_mask:0xf bank_mask:0xf
    v_mov_b32 v24, v20
    v_mov_b32 v25, v21
    v_mov_b32 v26, v22
    v_mov_b32 v27, v23
    s_nop 1
    v_permlane16_swap_b32 v24, v20
    v_permlane16_swap_b32 v25, v21
    v_permlane16_swap_b32 v26, v22
    v_permlane16_swap_b32 v27, v23
    s_nop 1
    v_add_f32 v20, v20, v24
    v_add_f32 v21, v21, v25
    v_add_f32 v22, v22, v26
    v_add_f32 v23, v23, v27
    v_mov_b32 v24, v20
    v_mov_b32 v25, v21
    v_mov_b32 v26, v22
    v_mov_b32 v27, v23
    s_nop 1
    v_permlane32_swap_b32 v24, v20
    v_permlane32_swap_b32 v25, v21
    v_permlane32_swap_b32 v26, v22
    v_permlane32_swap_b32 v27, v23
    s_nop 1
    v_add_f32 v20, v20, v24
    v_add_f32 v21, v21, v25
    v_add_f32 v22, v22, v26
    v_add_f32 v23, v23, v27
    v_cvt_pk_bf16_f32 v24, v20, v20
    v_cvt_pk_bf16_f32 v25, v21, v21
    v_cvt_pk_bf16_f32 v26, v22, v22
    v_cvt_pk_bf16_f32 v27, v23, v23
    v_and_or_b32 v44, v24, v10, s3
    v_and_or_b32 v45, v25, v10, s3
    v_and_or_b32 v46, v26, v10, s3
    v_and_or_b32 v47, v27, v10, s3
    s_add_u32 s59, s96, 1048576
    buffer_store_dwordx4 v[44:47], v7, s[36:39], s59 offen
    s_add_u32 s59, s96, 1081344
    buffer_store_dwordx4 v[44:47], v7, s[36:39], s59 offen
    s_mov_b32 s57, 0
    s_branch L_pq_ld
L_pq:
    s_sleep 2
    s_add_u32 s57, s57, 1
    s_cmp_ge_u32 s57, 48
    s_cbranch_scc1 L_pq_slow
L_pq_ld:
    buffer_load_dwordx4 v[96:99], v4, s[36:39], s93 offen sc1
    buffer_load_dwordx4 v[100:103], v4, s[36:39], s93 offen offset:1024 sc1
    s_waitcnt vmcnt(0)
    v_msad_u8 v12, v96, v19, 0
    v_msad_u8 v13, v97, v19, 0
    v_msad_u8 v12, v98, v19, v12
    v_msad_u8 v13, v99, v19, v13
    v_msad_u8 v12, v100, v19, v12
    v_msad_u8 v13, v101, v19, v13
    v_msad_u8 v12, v102, v19, v12
    v_msad_u8 v13, v103, v19, v13
    v_or_b32 v12, v12, v13
    v_cmp_ne_u32 vcc, 0, v12
    s_cbranch_vccnz L_pq
    s_branch L_pq_done
L_pq_slow:
    s_and_b32 s91, s57, 15
    s_cmp_eq_u32 s91, 0
    s_cbranch_scc0 L_pq_nf
    s_mov_b32 exec_hi, 0
    s_add_u32 s59, s96, s97
    s_add_u32 s91, s59, 524288
    buffer_store_dwordx4 v[48:51], v1, s[36:39], s91 offen sc1
    s_add_u32 s91, s91, 16384
    buffer_store_dwordx4 v[52:55], v1, s[36:39], s91 offen sc1
    s_add_u32 s91, s91, 16384
    buffer_store_dwordx4 v[56:59], v1, s[36:39], s91 offen sc1
    s_add_u32 s91, s91, 16384
    buffer_store_dwordx4 v[60:63], v1, s[36:39], s91 offen sc1
    s_mov_b64 exec, -1
    s_add_u32 s91, s59, 1048576
    buffer_store_dwordx4 v[44:47], v7, s[36:39], s91 offen sc1
    s_add_u32 s91, s59, 1081344
    buffer_store_dwordx4 v[44:47], v7, s[36:39], s91 offen sc1
L_pq_nf:
    s_mov_b32 s90, s93
    s_bitcmp1_b32 s57, 0
    s_cbranch_scc0 L_pq_c1
    s_add_u32 s90, s93, s97
L_pq_c1:
    buffer_load_dwordx4 v[96:99], v4, s[36:39], s90 offen sc1
    buffer_load_dwordx4 v[100:103], v4, s[36:39], s90 offen offset:1024 sc1
    s_waitcnt vmcnt(0)
    v_msad_u8 v12, v96, v19, 0
    v_msad_u8 v13, v97, v19, 0
    v_msad_u8 v12, v98, v19, v12
    v_msad_u8 v13, v99, v19, v13
    v_msad_u8 v12, v100, v19, v12
    v_msad_u8 v13, v101, v19, v13
    v_msad_u8 v12, v102, v19, v12
    v_msad_u8 v13, v103, v19, v13
    v_or_b32 v12, v12, v13
    v_cmp_ne_u32 vcc, 0, v12
    s_cbranch_vccz L_pq_done
    s_sleep 2
    s_add_u32 s57, s57, 1
    s_cmp_lt_u32 s57, 20000
    s_cbranch_scc1 L_pq_slow
L_pq_done:
    s_mov_b32 s3, 0x07060302
    v_perm_b32 v20, v97, v96, s3
    v_perm_b32 v21, v99, v98, s3
    v_perm_b32 v22, v101, v100, s3
    v_perm_b32 v23, v103, v102, s3
    ds_write_b64 v5, v[20:21]
    ds_write_b64 v5, v[22:23] offset:512
L_skipq:
    v_mov_b32 v12, 134224
    v_mov_b32 v13, 1
    s_waitcnt lgkmcnt(0)
    ds_write_b32 v12, v13
    v_mul_u32_u24 v6, 3584, v3
    v_lshl_add_u32 v6, v2, 4, v6
    v_add_u32 v6, 4096, v6
    v_lshlrev_b32 v5, 7, v2
    v_lshl_add_u32 v4, v3, 4, v5
    v_add_u32 v5, 64, v5
    s_lshl_b32 s92, s58, 12
    s_add_u32 s92, s92, 2097152
    v_mov_b32 v88, 0
    v_mov_b32 v89, 0
    v_mov_b32 v90, 0
    v_mov_b32 v91, 0
    v_mov_b32 v92, 0
    v_mov_b32 v93, 0
    v_mov_b32 v94, 0
    v_mov_b32 v95, 0
    v_mov_b32 v96, 0
    v_mov_b32 v97, 0
    v_mov_b32 v98, 0
    v_mov_b32 v99, 0
    v_mov_b32 v100, 0
    v_mov_b32 v101, 0
    v_mov_b32 v102, 0
    v_mov_b32 v103, 0
    v_lshl_add_u32 v8, v2, 1, v3
    v_lshlrev_b32 v8, 12, v8
    s_lshl_b32 s95, s58, 4
    s_add_u32 s95, s95, 4194304
    s_mov_b32 s101, 0
    v_mov_b32 v9, 134252
    s_mov_b32 s57, 0
    s_branch L_pm_ld
L_pm:
    s_sleep 1
    s_add_u32 s57, s57, 1
    s_cmp_ge_u32 s57, 48
    s_cbranch_scc1 L_pm_slow
L_pm_ld:
    buffer_load_dwordx4 v[28:31], v5, s[36:39], s92 offen sc1
    buffer_load_dwordx4 v[32:35], v5, s[36:39], s92 offen offset:2048 sc1
    buffer_load_dwordx4 v[36:39], v4, s[36:39], s92 offen sc1
    buffer_load_dwordx4 v[40:43], v4, s[36:39], s92 offen offset:2048 sc1
    s_cmp_eq_u32 s101, 1
    s_cbranch_scc1 L_wo_skipf
    ds_read_b32 v10, v9
    s_waitcnt lgkmcnt(0)
    v_readfirstlane_b32 s91, v10
    s_cmp_ge_u32 s91, 2
    s_cbranch_scc0 L_wo_skipf
    ds_read_b128 v[104:107], v6 offset:0
    ds_read_b128 v[108:111], v6 offset:256
    ds_read_b128 v[112:115], v6 offset:512
    ds_read_b128 v[116:119], v6 offset:768
    ds_read_b128 v[120:123], v6 offset:896
    ds_read_b128 v[124:127], v6 offset:1152
    ds_read_b128 v[128:131], v6 offset:1408
    ds_read_b128 v[132:135], v6 offset:1664
    ds_read_b128 v[136:139], v6 offset:1792
    ds_read_b128 v[140:143], v6 offset:2048
    ds_read_b128 v[144:147], v6 offset:2304
    ds_read_b128 v[148:151], v6 offset:2560
    ds_read_b128 v[152:155], v6 offset:2688
    ds_read_b128 v[156:159], v6 offset:2944
    ds_read_b128 v[160:163], v6 offset:3200
    ds_read_b128 v[164:167], v6 offset:3456
    s_mov_b32 s101, 1
L_wo_skipf:
    s_waitcnt vmcnt(0)
    v_msad_u8 v12, v28, v19, 0
    v_msad_u8 v13, v29, v19, 0
    v_msad_u8 v12, v30, v19, v12
    v_msad_u8 v13, v31, v19, v13
    v_msad_u8 v12, v32, v19, v12
    v_msad_u8 v13, v33, v19, v13
    v_msad_u8 v12, v34, v19, v12
    v_msad_u8 v13, v35, v19, v13
    v_or_b32 v12, v12, v13
    v_cmp_ne_u32 vcc, 0, v12
    s_cbranch_vccnz L_pm
    s_branch L_pm_done
L_pm_slow:
    s_and_b32 s91, s57, 15
    s_cmp_eq_u32 s91, 0
    s_cbranch_scc0 L_pm_nf
    s_mov_b32 exec_hi, 0
    s_add_u32 s59, s96, s97
    s_add_u32 s91, s59, 524288
    buffer_store_dwordx4 v[48:51], v1, s[36:39], s91 offen sc1
    s_add_u32 s91, s91, 16384
    buffer_store_dwordx4 v[52:55], v1, s[36:39], s91 offen sc1
    s_add_u32 s91, s91, 16384
    buffer_store_dwordx4 v[56:59], v1, s[36:39], s91 offen sc1
    s_add_u32 s91, s91, 16384
    buffer_store_dwordx4 v[60:63], v1, s[36:39], s91 offen sc1
    s_mov_b64 exec, -1
    s_add_u32 s91, s59, 1048576
    buffer_store_dwordx4 v[44:47], v7, s[36:39], s91 offen sc1
    s_add_u32 s91, s59, 1081344
    buffer_store_dwordx4 v[44:47], v7, s[36:39], s91 offen sc1
L_pm_nf:
    s_mov_b32 s90, s92
    s_bitcmp1_b32 s57, 0
    s_cbranch_scc0 L_pm_c1
    s_add_u32 s90, s92, s97
L_pm_c1:
    buffer_load_dwordx4 v[28:31], v5, s[36:39], s90 offen sc1
    buffer_load_dwordx4 v[32:35], v5, s[36:39], s90 offen offset:2048 sc1
    buffer_load_dwordx4 v[36:39], v4, s[36:39], s90 offen sc1
    buffer_load_dwordx4 v[40:43], v4, s[36:39], s90 offen offset:2048 sc1
    s_cmp_eq_u32 s101, 1
    s_cbranch_scc1 L_wo_skips
    ds_read_b32 v10, v9
    s_waitcnt lgkmcnt(0)
    v_readfirstlane_b32 s91, v10
    s_cmp_ge_u32 s91, 2
    s_cbranch_scc0 L_wo_skips
    ds_read_b128 v[104:107], v6 offset:0
    ds_read_b128 v[108:111], v6 offset:256
    ds_read_b128 v[112:115], v6 offset:512
    ds_read_b128 v[116:119], v6 offset:768
    ds_read_b128 v[120:123], v6 offset:896
    ds_read_b128 v[124:127], v6 offset:1152
    ds_read_b128 v[128:131], v6 offset:1408
    ds_read_b128 v[132:135], v6 offset:1664
    ds_read_b128 v[136:139], v6 offset:1792
    ds_read_b128 v[140:143], v6 offset:2048
    ds_read_b128 v[144:147], v6 offset:2304
    ds_read_b128 v[148:151], v6 offset:2560
    ds_read_b128 v[152:155], v6 offset:2688
    ds_read_b128 v[156:159], v6 offset:2944
    ds_read_b128 v[160:163], v6 offset:3200
    ds_read_b128 v[164:167], v6 offset:3456
    s_mov_b32 s101, 1
L_wo_skips:
    s_waitcnt vmcnt(0)
    v_msad_u8 v12, v28, v19, 0
    v_msad_u8 v13, v29, v19, 0
    v_msad_u8 v12, v30, v19, v12
    v_msad_u8 v13, v31, v19, v13
    v_msad_u8 v12, v32, v19, v12
    v_msad_u8 v13, v33, v19, v13
    v_msad_u8 v12, v34, v19, v12
    v_msad_u8 v13, v35, v19, v13
    v_or_b32 v12, v12, v13
    v_cmp_ne_u32 vcc, 0, v12
    s_cbranch_vccz L_pm_done
    s_sleep 2
    s_add_u32 s57, s57, 1
    s_cmp_lt_u32 s57, 20000
    s_cbranch_scc1 L_pm_slow
L_pm_done:
    v_max_f32 v20, v28, v32
    s_nop 1
    v_max_f32_dpp v20, v20, v20 row_ror:8 row_mask:0xf bank_mask:0xf
    s_nop 1
    v_max_f32_dpp v20, v20, v20 row_ror:4 row_mask:0xf bank_mask:0xf
    s_nop 1
    v_max_f32_dpp v20, v20, v20 row_ror:2 row_mask:0xf bank_mask:0xf
    s_nop 1
    v_max_f32_dpp v20, v20, v20 row_ror:1 row_mask:0xf bank_mask:0xf
    s_nop 1
    v_sub_f32 v21, v28, v20
    v_sub_f32 v22, v32, v20
    v_exp_f32 v21, v21
    v_exp_f32 v22, v22
    s_nop 0
    v_mul_f32 v23, v21, v29
    v_fma_f32 v23, v22, v33, v23
    s_nop 1
    v_add_f32_dpp v23, v23, v23 row_ror:8 row_mask:0xf bank_mask:0xf
    s_nop 1
    v_add_f32_dpp v23, v23, v23 row_ror:4 row_mask:0xf bank_mask:0xf
    s_nop 1
    v_add_f32_dpp v23, v23, v23 row_ror:2 row_mask:0xf bank_mask:0xf
    s_nop 1
    v_add_f32_dpp v23, v23, v23 row_ror:1 row_mask:0xf bank_mask:0xf
    s_nop 1
    v_rcp_f32 v23, v23
    s_nop 0
    v_mul_f32 v10, v21, v23
    v_mul_f32 v11, v22, v23
    s_cmp_eq_u32 s101, 1
    s_cbranch_scc1 L_wo_ok
    v_mov_b32 v12, 134252
    s_mov_b32 s57, 0
L_wow:
    ds_read_b32 v13, v12
    s_waitcnt lgkmcnt(0)
    v_readfirstlane_b32 s59, v13
    s_cmp_eq_u32 s59, 2
    s_cbranch_scc1 L_wow_ok
    s_sleep 1
    s_add_u32 s57, s57, 1
    s_cmp_lt_u32 s57, 400000
    s_cbranch_scc1 L_wow
L_wow_ok:
    ds_read_b128 v[104:107], v6 offset:0
    ds_read_b128 v[108:111], v6 offset:256
    ds_read_b128 v[112:115], v6 offset:512
    ds_read_b128 v[116:119], v6 offset:768
    ds_read_b128 v[120:123], v6 offset:896
    ds_read_b128 v[124:127], v6 offset:1152
    ds_read_b128 v[128:131], v6 offset:1408
    ds_read_b128 v[132:135], v6 offset:1664
    ds_read_b128 v[136:139], v6 offset:1792
    ds_read_b128 v[140:143], v6 offset:2048
    ds_read_b128 v[144:147], v6 offset:2304
    ds_read_b128 v[148:151], v6 offset:2560
    ds_read_b128 v[152:155], v6 offset:2688
    ds_read_b128 v[156:159], v6 offset:2944
    ds_read_b128 v[160:163], v6 offset:3200
    ds_read_b128 v[164:167], v6 offset:3456
L_wo_ok:
    s_mov_b32 s57, 0
    s_branch L_po_ld
L_po:
    s_sleep 1
    s_add_u32 s57, s57, 1
    s_cmp_ge_u32 s57, 48
    s_cbranch_scc1 L_po_slow
L_po_ld:
    buffer_load_dwordx4 v[36:39], v4, s[36:39], s92 offen sc1
    buffer_load_dwordx4 v[40:43], v4, s[36:39], s92 offen offset:2048 sc1
    s_waitcnt vmcnt(0)
    v_msad_u8 v12, v36, v19, 0
    v_msad_u8 v13, v37, v19, 0
    v_msad_u8 v12, v38, v19, v12
    v_msad_u8 v13, v39, v19, v13
    v_msad_u8 v12, v40, v19, v12
    v_msad_u8 v13, v41, v19, v13
    v_msad_u8 v12, v42, v19, v12
    v_msad_u8 v13, v43, v19, v13
    v_or_b32 v12, v12, v13
    v_cmp_ne_u32 vcc, 0, v12
    s_cbranch_vccnz L_po
    s_branch L_po_done
L_po_slow:
    s_and_b32 s91, s57, 15
    s_cmp_eq_u32 s91, 0
    s_cbranch_scc0 L_po_nf
    s_mov_b32 exec_hi, 0
    s_add_u32 s59, s96, s97
    s_add_u32 s91, s59, 524288
    buffer_store_dwordx4 v[48:51], v1, s[36:39], s91 offen sc1
    s_add_u32 s91, s91, 16384
    buffer_store_dwordx4 v[52:55], v1, s[36:39], s91 offen sc1
    s_add_u32 s91, s91, 16384
    buffer_store_dwordx4 v[56:59], v1, s[36:39], s91 offen sc1
    s_add_u32 s91, s91, 16384
    buffer_store_dwordx4 v[60:63], v1, s[36:39], s91 offen sc1
    s_mov_b64 exec, -1
    s_add_u32 s91, s59, 1048576
    buffer_store_dwordx4 v[44:47], v7, s[36:39], s91 offen sc1
    s_add_u32 s91, s59, 1081344
    buffer_store_dwordx4 v[44:47], v7, s[36:39], s91 offen sc1
L_po_nf:
    s_mov_b32 s90, s92
    s_bitcmp1_b32 s57, 0
    s_cbranch_scc0 L_po_c1
    s_add_u32 s90, s92, s97
L_po_c1:
    buffer_load_dwordx4 v[36:39], v4, s[36:39], s90 offen sc1
    buffer_load_dwordx4 v[40:43], v4, s[36:39], s90 offen offset:2048 sc1
    s_waitcnt vmcnt(0)
    v_msad_u8 v12, v36, v19, 0
    v_msad_u8 v13, v37, v19, 0
    v_msad_u8 v12, v38, v19, v12
    v_msad_u8 v13, v39, v19, v13
    v_msad_u8 v12, v40, v19, v12
    v_msad_u8 v13, v41, v19, v13
    v_msad_u8 v12, v42, v19, v12
    v_msad_u8 v13, v43, v19, v13
    v_or_b32 v12, v12, v13
    v_cmp_ne_u32 vcc, 0, v12
    s_cbranch_vccz L_po_done
    s_sleep 2
    s_add_u32 s57, s57, 1
    s_cmp_lt_u32 s57, 20000
    s_cbranch_scc1 L_po_slow
L_po_done:
    v_mul_f32 v24, v10, v36
    v_mul_f32 v25, v10, v37
    v_mul_f32 v26, v10, v38
    v_mul_f32 v27, v10, v39
    v_fma_f32 v24, v11, v40, v24
    v_fma_f32 v25, v11, v41, v25
    v_fma_f32 v26, v11, v42, v26
    v_fma_f32 v27, v11, v43, v27
    v_add_f32_dpp v24, v24, v24 row_ror:8 row_mask:0xf bank_mask:0xf
    v_add_f32_dpp v25, v25, v25 row_ror:8 row_mask:0xf bank_mask:0xf
    v_add_f32_dpp v26, v26, v26 row_ror:8 row_mask:0xf bank_mask:0xf
    v_add_f32_dpp v27, v27, v27 row_ror:8 row_mask:0xf bank_mask:0xf
    v_add_f32_dpp v24, v24, v24 row_ror:4 row_mask:0xf bank_mask:0xf
    v_add_f32_dpp v25, v25, v25 row_ror:4 row_mask:0xf bank_mask:0xf
    v_add_f32_dpp v26, v26, v26 row_ror:4 row_mask:0xf bank_mask:0xf
    v_add_f32_dpp v27, v27, v27 row_ror:4 row_mask:0xf bank_mask:0xf
    v_add_f32_dpp v24, v24, v24 row_ror:2 row_mask:0xf bank_mask:0xf
    v_add_f32_dpp v25, v25, v25 row_ror:2 row_mask:0xf bank_mask:0xf
    v_add_f32_dpp v26, v26, v26 row_ror:2 row_mask:0xf bank_mask:0xf
    v_add_f32_dpp v27, v27, v27 row_ror:2 row_mask:0xf bank_mask:0xf
    v_add_f32_dpp v24, v24, v24 row_ror:1 row_mask:0xf bank_mask:0xf
    v_add_f32_dpp v25, v25, v25 row_ror:1 row_mask:0xf bank_mask:0xf
    v_add_f32_dpp v26, v26, v26 row_ror:1 row_mask:0xf bank_mask:0xf
    v_add_f32_dpp v27, v27, v27 row_ror:1 row_mask:0xf bank_mask:0xf
    v_cvt_pk_bf16_f32 v24, v24, v24
    v_cvt_pk_bf16_f32 v25, v25, v25
    v_cvt_pk_bf16_f32 v26, v26, v26
    v_cvt_pk_bf16_f32 v27, v27, v27
    v_and_b32 v64, v24, v14
    v_and_b32 v65, v24, v15
    v_and_b32 v66, v24, v16
    v_and_b32 v67, v24, v17
    v_and_b32 v68, v25, v14
    v_and_b32 v69, v25, v15
    v_and_b32 v70, v25, v16
    v_and_b32 v71, v25, v17
    v_and_b32 v72, v26, v14
    v_and_b32 v73, v26, v15
    v_and_b32 v74, v26, v16
    v_and_b32 v75, v26, v17
    v_and_b32 v76, v27, v14
    v_and_b32 v77, v27, v15
    v_and_b32 v78, v27, v16
    v_and_b32 v79, v27, v17
    s_waitcnt lgkmcnt(0)
    s_nop 0
    v_mfma_f32_16x16x32_bf16 v[88:91], v[64:67], v[104:107], v[88:91]
    v_mfma_f32_16x16x32_bf16 v[88:91], v[68:71], v[120:123], v[88:91]
    v_mfma_f32_16x16x32_bf16 v[88:91], v[72:75], v[136:139], v[88:91]
    v_mfma_f32_16x16x32_bf16 v[88:91], v[76:79], v[152:155], v[88:91]
    v_mfma_f32_16x16x32_bf16 v[92:95], v[64:67], v[108:111], v[92:95]
    v_mfma_f32_16x16x32_bf16 v[92:95], v[68:71], v[124:127], v[92:95]
    v_mfma_f32_16x16x32_bf16 v[92:95], v[72:75], v[140:143], v[92:95]
    v_mfma_f32_16x16x32_bf16 v[92:95], v[76:79], v[156:159], v[92:95]
    v_mfma_f32_16x16x32_bf16 v[96:99], v[64:67], v[112:115], v[96:99]
    v_mfma_f32_16x16x32_bf16 v[96:99], v[68:71], v[128:131], v[96:99]
    v_mfma_f32_16x16x32_bf16 v[96:99], v[72:75], v[144:147], v[96:99]
    v_mfma_f32_16x16x32_bf16 v[96:99], v[76:79], v[160:163], v[96:99]
    v_mfma_f32_16x16x32_bf16 v[100:103], v[64:67], v[116:119], v[100:103]
    v_mfma_f32_16x16x32_bf16 v[100:103], v[68:71], v[132:135], v[100:103]
    v_mfma_f32_16x16x32_bf16 v[100:103], v[72:75], v[148:151], v[100:103]
    v_mfma_f32_16x16x32_bf16 v[100:103], v[76:79], v[164:167], v[100:103]
    s_mov_b32 exec_hi, 0
    v_bfi_b32 v88, v18, v88, s51
    v_bfi_b32 v89, v18, v89, s51
    v_bfi_b32 v90, v18, v90, s51
    v_bfi_b32 v91, v18, v91, s51
    buffer_store_dwordx4 v[88:91], v8, s[36:39], s95 offen sc1
    v_bfi_b32 v92, v18, v92, s51
    v_bfi_b32 v93, v18, v93, s51
    v_bfi_b32 v94, v18, v94, s51
    v_bfi_b32 v95, v18, v95, s51
    s_add_u32 s95, s95, 131072
    buffer_store_dwordx4 v[92:95], v8, s[36:39], s95 offen sc1
    v_bfi_b32 v96, v18, v96, s51
    v_bfi_b32 v97, v18, v97, s51
    v_bfi_b32 v98, v18, v98, s51
    v_bfi_b32 v99, v18, v99, s51
    s_add_u32 s95, s95, 131072
    buffer_store_dwordx4 v[96:99], v8, s[36:39], s95 offen sc1
    s_nop 2
    v_bfi_b32 v100, v18, v100, s51
    v_bfi_b32 v101, v18, v101, s51
    v_bfi_b32 v102, v18, v102, s51
    v_bfi_b32 v103, v18, v103, s51
    s_add_u32 s95, s95, 131072
    buffer_store_dwordx4 v[100:103], v8, s[36:39], s95 offen sc1
    s_mov_b64 exec, -1
    v_mov_b32 v12, 134256
    v_mov_b32 v13, 1
    ds_write_b32 v12, v13
    s_cmp_ge_u32 s2, 112
    s_cbranch_scc1 L_comm_done
    v_lshlrev_b32 v4, 4, v0
    s_lshl_b32 s92, s2, 12
    s_add_u32 s92, s92, 4194304
    s_mov_b32 s57, 0
    s_sleep 14
    s_branch L_pp_ld
L_pp:
    s_sleep 2
    s_add_u32 s57, s57, 1
    s_cmp_ge_u32 s57, 48
    s_cbranch_scc1 L_pp_slow
L_pp_ld:
    buffer_load_dwordx4 v[104:107], v4, s[36:39], s92 offen offset:0 sc1
    buffer_load_dwordx4 v[108:111], v4, s[36:39], s92 offen offset:1024 sc1
    buffer_load_dwordx4 v[112:115], v4, s[36:39], s92 offen offset:2048 sc1
    buffer_load_dwordx4 v[116:119], v4, s[36:39], s92 offen offset:3072 sc1
    s_waitcnt vmcnt(0)
    v_msad_u8 v12, v104, v19, 0
    v_msad_u8 v13, v105, v19, 0
    v_msad_u8 v12, v106, v19, v12
    v_msad_u8 v13, v107, v19, v13
    v_msad_u8 v12, v108, v19, v12
    v_msad_u8 v13, v109, v19, v13
    v_msad_u8 v12, v110, v19, v12
    v_msad_u8 v13, v111, v19, v13
    v_msad_u8 v12, v112, v19, v12
    v_msad_u8 v13, v113, v19, v13
    v_msad_u8 v12, v114, v19, v12
    v_msad_u8 v13, v115, v19, v13
    v_msad_u8 v12, v116, v19, v12
    v_msad_u8 v13, v117, v19, v13
    v_msad_u8 v12, v118, v19, v12
    v_msad_u8 v13, v119, v19, v13
    v_or_b32 v12, v12, v13
    v_cmp_ne_u32 vcc, 0, v12
    s_cbranch_vccnz L_pp
    s_branch L_pp_done
L_pp_slow:
    s_and_b32 s91, s57, 15
    s_cmp_eq_u32 s91, 0
    s_cbranch_scc0 L_pp_nf
    s_mov_b32 exec_hi, 0
    s_add_u32 s59, s96, s97
    s_add_u32 s91, s59, 524288
    buffer_store_dwordx4 v[48:51], v1, s[36:39], s91 offen sc1
    s_add_u32 s91, s91, 16384
    buffer_store_dwordx4 v[52:55], v1, s[36:39], s91 offen sc1
    s_add_u32 s91, s91, 16384
    buffer_store_dwordx4 v[56:59], v1, s[36:39], s91 offen sc1
    s_add_u32 s91, s91, 16384
    buffer_store_dwordx4 v[60:63], v1, s[36:39], s91 offen sc1
    s_mov_b64 exec, -1
    s_add_u32 s91, s59, 1048576
    buffer_store_dwordx4 v[44:47], v7, s[36:39], s91 offen sc1
    s_add_u32 s91, s59, 1081344
    buffer_store_dwordx4 v[44:47], v7, s[36:39], s91 offen sc1
L_pp_nf:
    s_mov_b32 s90, s92
    buffer_load_dwordx4 v[104:107], v4, s[36:39], s90 offen offset:0 sc1
    buffer_load_dwordx4 v[108:111], v4, s[36:39], s90 offen offset:1024 sc1
    buffer_load_dwordx4 v[112:115], v4, s[36:39], s90 offen offset:2048 sc1
    buffer_load_dwordx4 v[116:119], v4, s[36:39], s90 offen offset:3072 sc1
    s_waitcnt vmcnt(0)
    v_msad_u8 v12, v104, v19, 0
    v_msad_u8 v13, v105, v19, 0
    v_msad_u8 v12, v106, v19, v12
    v_msad_u8 v13, v107, v19, v13
    v_msad_u8 v12, v108, v19, v12
    v_msad_u8 v13, v109, v19, v13
    v_msad_u8 v12, v110, v19, v12
    v_msad_u8 v13, v111, v19, v13
    v_msad_u8 v12, v112, v19, v12
    v_msad_u8 v13, v113, v19, v13
    v_msad_u8 v12, v114, v19, v12
    v_msad_u8 v13, v115, v19, v13
    v_msad_u8 v12, v116, v19, v12
    v_msad_u8 v13, v117, v19, v13
    v_msad_u8 v12, v118, v19, v12
    v_msad_u8 v13, v119, v19, v13
    v_or_b32 v12, v12, v13
    v_cmp_ne_u32 vcc, 0, v12
    s_cbranch_vccz L_pp_done
    s_sleep 2
    s_add_u32 s57, s57, 1
    s_cmp_lt_u32 s57, 20000
    s_cbranch_scc1 L_pp_slow
L_pp_done:
    v_add_f32 v8, v104, v108
    v_add_f32 v20, v112, v116
    v_add_f32 v9, v105, v109
    v_add_f32 v21, v113, v117
    v_add_f32 v10, v106, v110
    v_add_f32 v22, v114, v118
    v_add_f32 v11, v107, v111
    v_add_f32 v23, v115, v119
    v_add_f32 v8, v8, v20
    v_add_f32 v9, v9, v21
    v_add_f32 v10, v10, v22
    v_add_f32 v11, v11, v23
    v_add_f32_dpp v8, v8, v8 row_ror:8 row_mask:0xf bank_mask:0xf
    v_add_f32_dpp v9, v9, v9 row_ror:8 row_mask:0xf bank_mask:0xf
    v_add_f32_dpp v10, v10, v10 row_ror:8 row_mask:0xf bank_mask:0xf
    v_add_f32_dpp v11, v11, v11 row_ror:8 row_mask:0xf bank_mask:0xf
    v_add_f32_dpp v8, v8, v8 row_ror:4 row_mask:0xf bank_mask:0xf
    v_add_f32_dpp v9, v9, v9 row_ror:4 row_mask:0xf bank_mask:0xf
    v_add_f32_dpp v10, v10, v10 row_ror:4 row_mask:0xf bank_mask:0xf
    v_add_f32_dpp v11, v11, v11 row_ror:4 row_mask:0xf bank_mask:0xf
    v_add_f32_dpp v8, v8, v8 row_ror:2 row_mask:0xf bank_mask:0xf
    v_add_f32_dpp v9, v9, v9 row_ror:2 row_mask:0xf bank_mask:0xf
    v_add_f32_dpp v10, v10, v10 row_ror:2 row_mask:0xf bank_mask:0xf
    v_add_f32_dpp v11, v11, v11 row_ror:2 row_mask:0xf bank_mask:0xf
    v_add_f32_dpp v8, v8, v8 row_ror:1 row_mask:0xf bank_mask:0xf
    v_add_f32_dpp v9, v9, v9 row_ror:1 row_mask:0xf bank_mask:0xf
    v_add_f32_dpp v10, v10, v10 row_ror:1 row_mask:0xf bank_mask:0xf
    v_add_f32_dpp v11, v11, v11 row_ror:1 row_mask:0xf bank_mask:0xf
    v_mov_b32 v20, v8
    v_mov_b32 v21, v9
    v_mov_b32 v22, v10
    v_mov_b32 v23, v11
    s_nop 1
    v_permlane16_swap_b32 v20, v8
    v_permlane16_swap_b32 v21, v9
    v_permlane16_swap_b32 v22, v10
    v_permlane16_swap_b32 v23, v11
    s_nop 1
    v_add_f32 v8, v8, v20
    v_add_f32 v9, v9, v21
    v_add_f32 v10, v10, v22
    v_add_f32 v11, v11, v23
    v_mov_b32 v20, v8
    v_mov_b32 v21, v9
    v_mov_b32 v22, v10
    v_mov_b32 v23, v11
    s_nop 1
    v_permlane32_swap_b32 v20, v8
    v_permlane32_swap_b32 v21, v9
    v_permlane32_swap_b32 v22, v10
    v_permlane32_swap_b32 v23, v11
    s_nop 1
    v_add_f32 v8, v8, v20
    v_add_f32 v9, v9, v21
    v_add_f32 v10, v10, v22
    v_add_f32 v11, v11, v23
    v_cvt_pk_bf16_f32 v8, v8, v9
    v_cvt_pk_bf16_f32 v9, v10, v11
    s_lshl_b32 s52, s2, 3
    v_mov_b32 v4, 0
    s_mov_b64 exec, 1
    buffer_store_dwordx2 v[8:9], v4, s[44:47], s52 offen
    s_cmp_eq_u32 s2, 0
    s_cbranch_scc0 L_noepoch
    v_mov_b32 v10, s51
    buffer_store_dword v10, v4, s[36:39], 0 offen offset:0 sc1
L_noepoch:
    s_mov_b64 exec, -1
L_comm_done:
L_end:
    s_endpgm
L_codeend:
.section .rodata,"a"
.p2align 6
.amdhsa_kernel standalone__gqa_block_cached__decode_kernel
  .amdhsa_next_free_vgpr 168
  .amdhsa_next_free_sgpr 102
  .amdhsa_accum_offset 168
  .amdhsa_group_segment_fixed_size 0
  .amdhsa_kernarg_size 64
  .amdhsa_user_sgpr_count 2
  .amdhsa_user_sgpr_kernarg_segment_ptr 1
  .amdhsa_system_sgpr_workgroup_id_x 1
.end_amdhsa_kernel
```
